```python
import torch

def _softmax(x, axis=-1):
    return torch.softmax(x, dim=axis)
def _gelu(x):
    return torch.nn.functional.gelu(x, approximate="tanh")
def _silu(x):
    return torch.nn.functional.silu(x)
def _sigmoid(x):
    return torch.sigmoid(x)
def _layernorm(x, axis=-1, eps=1e-5):
    m = x.mean(dim=axis, keepdim=True)
    v = x.var(dim=axis, keepdim=True, unbiased=False)
    return (x - m) / torch.sqrt(v + eps)
def _scatter_add(tgt, idx, src, axis=0):
    return tgt.clone().index_add_(axis, idx, src)
def _segment_sum(src, seg, n):
    out = torch.zeros((n,) + src.shape[1:], dtype=src.dtype)
    return out.index_add_(0, seg, src)
def _pad(x, pw):
    flat = tuple(v for pair in reversed(pw) for v in pair)
    return torch.nn.functional.pad(x, flat)

kernel_name = 'standalone__edge_featured_mpnn_mpnn__graph'

def setup_inputs():

    _w = (lambda a: (lambda t: t.to(torch.bfloat16) if t.is_floating_point() else t)(torch.as_tensor(a)))
    N, deg, D, De = 50000, 16, 64, max(4, 1)
    E = N * deg
    H = 2 * D
    return {
        "x": _w((lambda *s: torch.randn(*s, dtype=torch.bfloat16) * 0.05)(N, D)),
        "e_attr": _w((lambda *s: torch.randn(*s, dtype=torch.bfloat16) * 1.6)(E, De)),
        "src": _w((lambda lo, hi, *s: torch.randint(lo, hi, s))(0, N, E).to(torch.int64)),
        "dst": _w((lambda lo, hi, *s: torch.randint(lo, hi, s))(0, N, E).to(torch.int64)),
        "w1": _w((lambda *s: torch.randn(*s, dtype=torch.bfloat16) * 1.6)(2 * D + De, H) * (1.0 / (2 * D + De) ** 0.5)),
        "b1": _w((lambda *s: torch.randn(*s, dtype=torch.bfloat16) * 3.2)(H) * 0.01),
        "w2": _w((lambda *s: torch.randn(*s, dtype=torch.bfloat16) * 0.05)(H, D) * (1.0 / H ** 0.5)),
        "b2": _w((lambda *s: torch.randn(*s, dtype=torch.bfloat16) * 0.1)(D) * 0.01),
    }

def reference(x, e_attr, src, dst, w1, b1, w2, b2):
    N, D = x.shape
    h_src = x[src]
    h_dst = x[dst]
    m_in = torch.concatenate([h_src, h_dst, e_attr], axis=-1)
    h = _silu(m_in @ w1 + b1)
    msg = h @ w2 + b2
    return _segment_sum(msg, dst, N)
```

```asm
; @launch grid=(256,1,1) block=(256,1,1) lds=163216
.amdgcn_target "amdgcn-amd-amdhsa--gfx950"
.text
.globl standalone__edge_featured_mpnn_mpnn__graph_kernel
.type standalone__edge_featured_mpnn_mpnn__graph_kernel,@function
.p2align 12
.p2align 8
standalone__edge_featured_mpnn_mpnn__graph_kernel:
    s_cmp_ge_u32 s2, 256
    s_cbranch_scc1 K2_END
    s_load_dwordx16 s[72:87], s[0:1], 0
    s_load_dwordx2 s[44:45], s[0:1], 80
    s_load_dwordx2 s[42:43], s[0:1], 64
    s_getpc_b64 s[52:53]
K2_PC:
    v_lshlrev_b32 v2, 7, v0
    v_min_u32 v2, K2_SLOW-K2_PC, v2
    v_mov_b32 v3, 0
    v_lshl_add_u64 v[2:3], v[2:3], 0, s[52:53]
    global_load_dword v2, v[2:3], off
    v_mov_b32 v16, v0
    v_and_b32 v13, 63, v0
    v_lshrrev_b32 v1, 6, v0
    s_cmp_ge_u32 s2, 250
    v_readfirstlane_b32 s20, v1
    s_cbranch_scc1 K2_BUILD
    s_and_b32 s21, s2, 7
    s_lshl_b32 s21, s21, 5
    s_lshr_b32 s3, s2, 3
    s_add_u32 s21, s21, s3
    v_lshlrev_b32 v19, 4, v16
    v_lshlrev_b32 v25, 4, v13
    v_and_b32 v36, 31, v13
    v_mul_u32_u24 v17, 516, v16
    v_add_u32 v17, 62080, v17
    v_lshlrev_b32 v18, 2, v16
    v_mov_b32 v20, 0
    v_mov_b32 v21, 0
    v_lshlrev_b32 v26, 3, v13
    ds_write_b32 v18, v17 offset:0
    ds_write_b64 v26, v[20:21] offset:1024
    ds_write_b32 v18, v20 offset:5120
    s_mov_b32 s18, 578560
    s_mov_b32 s19, 0x00020000
    s_mov_b32 s6, 6400000
    s_mov_b32 s7, 0x00020000
    s_mov_b32 s10, 6400000
    s_mov_b32 s11, 0x00020000
    s_mov_b32 s14, 9600000
    s_mov_b32 s15, 0x00020000
    s_mov_b32 s40, 53248
    v_lshlrev_b32 v60, 5, v16
    v_lshl_add_u32 v61, v1, 5, v36
    v_lshlrev_b32 v62, 3, v61
    v_lshlrev_b32 v61, 2, v61
    s_mul_i32 s88, s2, 12800
    s_add_u32 s89, s88, 4096
    s_add_u32 s90, s88, 8192
    s_add_u32 s91, s88, 12288
    s_lshl_b32 s92, s88, 1
    s_lshl_b32 s93, s89, 1
    s_lshl_b32 s94, s90, 1
    s_lshl_b32 s95, s91, 1
    s_mov_b32 s58, 3200000
    s_mov_b32 s59, 0x00020000
    s_mov_b32 s62, 3200000
    s_mov_b32 s63, 0x00020000
    s_mov_b32 s66, 6400000
    s_mov_b32 s67, 0x00020000
    s_mov_b32 s70, 38400
    s_mov_b32 s71, 0x00020000
    s_mul_i32 s41, s2, 38400
    s_waitcnt lgkmcnt(0)
    s_mov_b64 s[56:57], s[78:79]
    buffer_load_dwordx4 v[64:67], v19, s[56:59], s88 offen
    buffer_load_dwordx4 v[68:71], v19, s[56:59], s89 offen
    buffer_load_dwordx4 v[72:75], v19, s[56:59], s90 offen
    s_mov_b32 exec_hi, 0
    buffer_load_dword v76, v61, s[56:59], s91 offen
    s_mov_b32 exec_hi, -1
    s_mov_b64 s[60:61], s[76:77]
    s_mov_b64 s[64:65], s[74:75]
    s_add_u32 s68, s44, s41
    s_addc_u32 s69, s45, 0
    s_add_u32 s16, s44, 9600000
    s_addc_u32 s17, s45, 0
    s_mov_b64 s[12:13], s[44:45]
    s_mov_b64 s[4:5], s[72:73]
    s_mov_b64 s[8:9], s[42:43]
    s_barrier
    buffer_load_dwordx4 v[80:83], v19, s[60:63], s88 offen
    buffer_load_dwordx4 v[128:131], v60, s[64:67], s92 offen
    buffer_load_dwordx4 v[132:135], v60, s[64:67], s92 offen offset:16
    s_movk_i32 s22, 128
    s_mov_b64 s[34:35], 0
    s_mov_b32 s32, 0
    s_mov_b32 s41, 0xffff
    v_and_b32 v27, 15, v13
    v_not_b32 v28, v27
    v_mul_u32_u24 v27, 12, v27
    v_lshrrev_b32 v11, 5, v13
    v_lshlrev_b32 v11, 6, v11
    v_mov_b32 v33, 12
    v_lshrrev_b32 v34, 3, v13
    v_lshlrev_b32 v34, 4, v34
    v_xor_b32 v34, v34, v25
    v_mul_u32_u24 v31, 38400, v16
    v_bfe_u32 v29, v36, 2, 1
    v_and_b32 v30, 1, v36
    v_lshl_or_b32 v29, v29, 1, v30
    v_bfe_u32 v30, v36, 1, 1
    v_lshl_or_b32 v29, v29, 1, v30
    v_lshrrev_b32 v30, 3, v36
    v_lshl_or_b32 v29, v29, 2, v30
    v_lshlrev_b32 v29, 2, v29
    s_lshl_b32 s27, s21, 3
    s_add_u32 s27, s27, 54272
    v_lshlrev_b32 v24, 11, v16
    v_add_u32 v24, s27, v24
    v_min_u32 v35, 5, v13
    v_add_u32 v35, 250, v35
    v_lshlrev_b32 v35, 11, v35
    v_add_u32 v35, s27, v35
    s_lshl_b32 s3, s20, 3
    s_or_b32 s3, s3, 0x80000
    v_lshrrev_b32 v37, 2, v36
    v_and_b32 v38, 1, v36
    v_lshl_or_b32 v37, v37, 1, v38
    v_bfe_u32 v38, v36, 1, 1
    s_bfe_u32 s38, 0x4040400, s3
    s_bfe_u32 s46, 0x4020000, s3
    s_bfe_u32 s47, 0x84684c1e, s3
    s_sub_u32 s47, s47, s38
    v_cmp_gt_u32 vcc, s38, v36
    v_add_u32 v44, s47, v36
    v_add_u32 v39, s46, v37
    v_cndmask_b32 v44, v44, v39, vcc
    v_lshlrev_b32 v44, 3, v44
    v_cndmask_b32 v46, 0, 1, vcc
    v_and_b32 v47, v46, v38
    v_sub_u32 v45, v46, v47
    v_lshlrev_b32 v48, 30, v47
    v_mul_u32_u24 v47, 12, v47
    s_bfe_u32 s29, 0x18181c20, s3
    s_bfe_u32 s46, 0x6123ea0, s3
    s_bfe_u32 s47, 0xb0b8c000, s3
    s_sub_u32 s47, s47, s29
    v_cmp_gt_u32 vcc, s29, v36
    v_add_u32 v50, s47, v36
    v_add_u32 v39, s46, v37
    v_cndmask_b32 v50, v50, v39, vcc
    v_lshlrev_b32 v50, 3, v50
    v_cndmask_b32 v52, 0, 1, vcc
    v_and_b32 v53, v52, v38
    v_sub_u32 v51, v52, v53
    v_lshlrev_b32 v54, 30, v53
    v_mul_u32_u24 v53, 12, v53
    s_mul_i32 s33, s20, 6144
    s_mul_i32 s39, s21, 25088
    s_add_u32 s39, s39, s33
    s_mul_i32 s46, s20, 13312
    s_lshl_b32 s47, s2, 11
    s_add_u32 s47, s47, 54272
    s_movk_i32 s96, -196
    s_movk_i32 s97, 7168
    s_waitcnt vmcnt(6)
    v_mul_u32_u24 v96, 85599, v64
    v_lshrrev_b32 v96, 22, v96
    v_and_b32 v96, 0x3fc, v96
    ds_add_rtn_u32 v112, v96, v33 offset:5120
    v_mul_u32_u24 v97, 85599, v65
    v_lshrrev_b32 v97, 22, v97
    v_and_b32 v97, 0x3fc, v97
    ds_add_rtn_u32 v113, v97, v33 offset:5120
    v_mul_u32_u24 v98, 85599, v66
    v_lshrrev_b32 v98, 22, v98
    v_and_b32 v98, 0x3fc, v98
    ds_add_rtn_u32 v114, v98, v33 offset:5120
    v_mul_u32_u24 v99, 85599, v67
    v_lshrrev_b32 v99, 22, v99
    v_and_b32 v99, 0x3fc, v99
    ds_add_rtn_u32 v115, v99, v33 offset:5120
    s_waitcnt vmcnt(5)
    v_mul_u32_u24 v100, 85599, v68
    v_lshrrev_b32 v100, 22, v100
    v_and_b32 v100, 0x3fc, v100
    ds_add_rtn_u32 v116, v100, v33 offset:5120
    v_mul_u32_u24 v101, 85599, v69
    v_lshrrev_b32 v101, 22, v101
    v_and_b32 v101, 0x3fc, v101
    ds_add_rtn_u32 v117, v101, v33 offset:5120
    v_mul_u32_u24 v102, 85599, v70
    v_lshrrev_b32 v102, 22, v102
    v_and_b32 v102, 0x3fc, v102
    ds_add_rtn_u32 v118, v102, v33 offset:5120
    v_mul_u32_u24 v103, 85599, v71
    v_lshrrev_b32 v103, 22, v103
    v_and_b32 v103, 0x3fc, v103
    ds_add_rtn_u32 v119, v103, v33 offset:5120
    s_waitcnt vmcnt(4)
    v_mul_u32_u24 v104, 85599, v72
    v_lshrrev_b32 v104, 22, v104
    v_and_b32 v104, 0x3fc, v104
    ds_add_rtn_u32 v120, v104, v33 offset:5120
    v_mul_u32_u24 v105, 85599, v73
    v_lshrrev_b32 v105, 22, v105
    v_and_b32 v105, 0x3fc, v105
    ds_add_rtn_u32 v121, v105, v33 offset:5120
    v_mul_u32_u24 v106, 85599, v74
    v_lshrrev_b32 v106, 22, v106
    v_and_b32 v106, 0x3fc, v106
    ds_add_rtn_u32 v122, v106, v33 offset:5120
    v_mul_u32_u24 v107, 85599, v75
    v_lshrrev_b32 v107, 22, v107
    v_and_b32 v107, 0x3fc, v107
    ds_add_rtn_u32 v123, v107, v33 offset:5120
    s_waitcnt vmcnt(3)
    s_mov_b32 exec_hi, 0
    v_mul_u32_u24 v108, 85599, v76
    v_lshrrev_b32 v108, 22, v108
    v_and_b32 v108, 0x3fc, v108
    ds_add_rtn_u32 v124, v108, v33 offset:5120
    s_mov_b32 exec_hi, -1
    buffer_load_dwordx4 v[84:87], v19, s[60:63], s89 offen
    buffer_load_dwordx4 v[136:139], v60, s[64:67], s93 offen
    buffer_load_dwordx4 v[140:143], v60, s[64:67], s93 offen offset:16
    buffer_load_dwordx4 v[88:91], v19, s[60:63], s90 offen
    buffer_load_dwordx4 v[144:147], v60, s[64:67], s94 offen
    buffer_load_dwordx4 v[148:151], v60, s[64:67], s94 offen offset:16
    s_mov_b32 exec_hi, 0
    buffer_load_dword v92, v61, s[60:63], s91 offen
    buffer_load_dwordx2 v[152:153], v62, s[64:67], s95 offen
    s_mov_b32 exec_hi, -1
    buffer_load_dwordx2 v[22:23], v20, s[16:19], s40 offen sc1
    v_lshlrev_b32 v64, 2, v64
    v_mad_i32_i24 v64, v96, s96, v64
    v_lshlrev_b32 v65, 2, v65
    v_mad_i32_i24 v65, v97, s96, v65
    v_lshlrev_b32 v66, 2, v66
    v_mad_i32_i24 v66, v98, s96, v66
    v_lshlrev_b32 v67, 2, v67
    v_mad_i32_i24 v67, v99, s96, v67
    v_lshlrev_b32 v68, 2, v68
    v_mad_i32_i24 v68, v100, s96, v68
    v_lshlrev_b32 v69, 2, v69
    v_mad_i32_i24 v69, v101, s96, v69
    v_lshlrev_b32 v70, 2, v70
    v_mad_i32_i24 v70, v102, s96, v70
    v_lshlrev_b32 v71, 2, v71
    v_mad_i32_i24 v71, v103, s96, v71
    v_lshlrev_b32 v72, 2, v72
    v_mad_i32_i24 v72, v104, s96, v72
    v_lshlrev_b32 v73, 2, v73
    v_mad_i32_i24 v73, v105, s96, v73
    v_lshlrev_b32 v74, 2, v74
    v_mad_i32_i24 v74, v106, s96, v74
    v_lshlrev_b32 v75, 2, v75
    v_mad_i32_i24 v75, v107, s96, v75
    v_lshlrev_b32 v76, 2, v76
    v_mad_i32_i24 v76, v108, s96, v76
    s_waitcnt lgkmcnt(0)
    s_barrier
    s_cmp_lg_u32 s20, 0
    s_cbranch_scc1 K2_SC
    ds_read_b128 v[4:7], v19 offset:5120
    s_waitcnt lgkmcnt(0)
    v_add_u32 v8, v4, v5
    v_add3_u32 v8, v8, v6, v7
    v_mov_b32 v9, v8
    s_nop 1
    v_add_u32_dpp v9, v9, v9 row_shr:1 row_mask:0xf bank_mask:0xf
    s_nop 1
    v_add_u32_dpp v9, v9, v9 row_shr:2 row_mask:0xf bank_mask:0xf
    s_nop 1
    v_add_u32_dpp v9, v9, v9 row_shr:4 row_mask:0xf bank_mask:0xf
    s_nop 1
    v_add_u32_dpp v9, v9, v9 row_shr:8 row_mask:0xf bank_mask:0xf
    s_nop 1
    v_add_u32_dpp v9, v9, v9 row_bcast:15 row_mask:0xa bank_mask:0xf
    s_nop 1
    v_add_u32_dpp v9, v9, v9 row_bcast:31 row_mask:0xc bank_mask:0xf
    v_sub_u32 v40, v9, v8
    v_add_u32 v41, v40, v4
    v_add_u32 v42, v41, v5
    v_add_u32 v43, v42, v6
    ds_write_b128 v19, v[40:43] offset:6144
    s_waitcnt lgkmcnt(0)
K2_SC:
    v_lshlrev_b32 v8, 3, v16
    s_barrier
    ds_read_b32 v96, v96 offset:6144
    ds_read_b32 v97, v97 offset:6144
    ds_read_b32 v98, v98 offset:6144
    ds_read_b32 v99, v99 offset:6144
    ds_read_b32 v100, v100 offset:6144
    s_waitcnt vmcnt(9)
    v_lshl_or_b32 v64, v80, 16, v64
    v_lshl_or_b32 v65, v81, 16, v65
    v_lshl_or_b32 v66, v82, 16, v66
    v_lshl_or_b32 v67, v83, 16, v67
    s_waitcnt lgkmcnt(4)
    v_add3_u32 v112, v112, v96, s97
    ds_write2_b32 v112, v128, v129 offset0:0 offset1:1
    ds_write_b32 v112, v64 offset:8
    ds_read_b32 v101, v101 offset:6144
    s_waitcnt lgkmcnt(6)
    v_add3_u32 v113, v113, v97, s97
    ds_write2_b32 v113, v130, v131 offset0:0 offset1:1
    ds_write_b32 v113, v65 offset:8
    ds_read_b32 v102, v102 offset:6144
    s_waitcnt lgkmcnt(8)
    v_add3_u32 v114, v114, v98, s97
    ds_write2_b32 v114, v132, v133 offset0:0 offset1:1
    ds_write_b32 v114, v66 offset:8
    ds_read_b32 v103, v103 offset:6144
    s_waitcnt lgkmcnt(10)
    v_add3_u32 v115, v115, v99, s97
    ds_write2_b32 v115, v134, v135 offset0:0 offset1:1
    ds_write_b32 v115, v67 offset:8
    ds_read_b32 v104, v104 offset:6144
    s_waitcnt vmcnt(6)
    v_lshl_or_b32 v68, v84, 16, v68
    v_lshl_or_b32 v69, v85, 16, v69
    v_lshl_or_b32 v70, v86, 16, v70
    v_lshl_or_b32 v71, v87, 16, v71
    s_waitcnt lgkmcnt(12)
    v_add3_u32 v116, v116, v100, s97
    ds_write2_b32 v116, v136, v137 offset0:0 offset1:1
    ds_write_b32 v116, v68 offset:8
    ds_read_b32 v105, v105 offset:6144
    s_waitcnt lgkmcnt(12)
    v_add3_u32 v117, v117, v101, s97
    ds_write2_b32 v117, v138, v139 offset0:0 offset1:1
    ds_write_b32 v117, v69 offset:8
    ds_read_b32 v106, v106 offset:6144
    s_waitcnt lgkmcnt(12)
    v_add3_u32 v118, v118, v102, s97
    ds_write2_b32 v118, v140, v141 offset0:0 offset1:1
    ds_write_b32 v118, v70 offset:8
    ds_read_b32 v107, v107 offset:6144
    s_waitcnt lgkmcnt(12)
    v_add3_u32 v119, v119, v103, s97
    ds_write2_b32 v119, v142, v143 offset0:0 offset1:1
    ds_write_b32 v119, v71 offset:8
    ds_read_b32 v108, v108 offset:6144
    s_waitcnt vmcnt(3)
    v_lshl_or_b32 v72, v88, 16, v72
    v_lshl_or_b32 v73, v89, 16, v73
    v_lshl_or_b32 v74, v90, 16, v74
    v_lshl_or_b32 v75, v91, 16, v75
    s_waitcnt lgkmcnt(12)
    v_add3_u32 v120, v120, v104, s97
    ds_write2_b32 v120, v144, v145 offset0:0 offset1:1
    ds_write_b32 v120, v72 offset:8
    s_waitcnt lgkmcnt(11)
    v_add3_u32 v121, v121, v105, s97
    ds_write2_b32 v121, v146, v147 offset0:0 offset1:1
    ds_write_b32 v121, v73 offset:8
    s_waitcnt lgkmcnt(10)
    v_add3_u32 v122, v122, v106, s97
    ds_write2_b32 v122, v148, v149 offset0:0 offset1:1
    ds_write_b32 v122, v74 offset:8
    s_waitcnt lgkmcnt(9)
    v_add3_u32 v123, v123, v107, s97
    ds_write2_b32 v123, v150, v151 offset0:0 offset1:1
    ds_write_b32 v123, v75 offset:8
    s_waitcnt vmcnt(1)
    v_lshl_or_b32 v76, v92, 16, v76
    s_waitcnt lgkmcnt(8)
    v_add3_u32 v124, v124, v108, s97
    s_mov_b32 exec_hi, 0
    ds_write2_b32 v124, v152, v153 offset0:0 offset1:1
    ds_write_b32 v124, v76 offset:8
    s_mov_b32 exec_hi, -1
    ds_read_b64 v[4:5], v8 offset:5120
    ds_read_b64 v[6:7], v8 offset:6144
    v_add_u32 v9, 7168, v19
    s_waitcnt vmcnt(0)
    v_add_u32 v22, 1, v22
    v_and_b32 v23, 0xff000000, v23
    s_waitcnt lgkmcnt(0)
    s_barrier
    ds_read_b128 v[64:67], v9 offset:0
    ds_read_b128 v[68:71], v9 offset:4096
    ds_read_b128 v[72:75], v9 offset:8192
    ds_read_b128 v[76:79], v9 offset:12288
    ds_read_b128 v[80:83], v9 offset:16384
    ds_read_b128 v[84:87], v9 offset:20480
    ds_read_b128 v[88:91], v9 offset:24576
    ds_read_b128 v[92:95], v9 offset:28672
    ds_read_b128 v[96:99], v9 offset:32768
    ds_read_b128 v[100:103], v9 offset:36864
    v_mul_u32_u24 v4, 5462, v4
    v_lshrrev_b32 v4, 16, v4
    v_mul_u32_u24 v5, 5462, v5
    v_lshrrev_b32 v5, 16, v5
    v_mul_u32_u24 v6, 5462, v6
    v_lshrrev_b32 v6, 16, v6
    v_mul_u32_u24 v7, 5462, v7
    v_lshrrev_b32 v7, 16, v7
    v_lshl_or_b32 v40, v4, 12, v6
    v_lshl_or_b32 v42, v5, 12, v7
    v_or_b32 v40, v40, v23
    v_or_b32 v42, v42, v23
    v_mov_b32 v41, v22
    v_mov_b32 v43, v22
    s_waitcnt lgkmcnt(9)
    buffer_store_dwordx4 v[64:67], v19, s[68:71], 0 offen sc1
    s_mov_b32 s84, 4096
    s_waitcnt lgkmcnt(8)
    buffer_store_dwordx4 v[68:71], v19, s[68:71], s84 offen sc1
    s_mov_b32 s84, 8192
    s_waitcnt lgkmcnt(7)
    buffer_store_dwordx4 v[72:75], v19, s[68:71], s84 offen sc1
    s_mov_b32 s84, 12288
    s_waitcnt lgkmcnt(6)
    buffer_store_dwordx4 v[76:79], v19, s[68:71], s84 offen sc1
    s_mov_b32 s84, 16384
    s_waitcnt lgkmcnt(5)
    buffer_store_dwordx4 v[80:83], v19, s[68:71], s84 offen sc1
    s_mov_b32 s84, 20480
    s_waitcnt lgkmcnt(4)
    buffer_store_dwordx4 v[84:87], v19, s[68:71], s84 offen sc1
    s_mov_b32 s84, 24576
    s_waitcnt lgkmcnt(3)
    buffer_store_dwordx4 v[88:91], v19, s[68:71], s84 offen sc1
    s_mov_b32 s84, 28672
    s_waitcnt lgkmcnt(2)
    buffer_store_dwordx4 v[92:95], v19, s[68:71], s84 offen sc1
    s_mov_b32 s84, 32768
    s_waitcnt lgkmcnt(1)
    buffer_store_dwordx4 v[96:99], v19, s[68:71], s84 offen sc1
    s_mov_b32 s84, 36864
    s_waitcnt lgkmcnt(0)
    buffer_store_dwordx4 v[100:103], v19, s[68:71], s84 offen sc1
    s_waitcnt vmcnt(0)
    s_barrier
    buffer_load_dwordx2 v[56:57], v35, s[16:19], 0 offen sc1
    s_cmp_ge_u32 s20, 2
    s_cselect_b64 exec, 0, -1
    buffer_store_dwordx4 v[40:43], v19, s[16:19], s47 offen sc1
    s_mov_b64 exec, -1
    s_waitcnt vmcnt(1)
    v_xor_b32 v36, v56, v23
    v_xor_b32 v37, v57, v22
    v_lshrrev_b32 v36, 24, v36
    v_or_b32 v36, v36, v37
    v_cmp_ne_u32 vcc, 0, v36
    s_cbranch_vccnz K2_WAITB
K2_WGO:
    s_add_u32 m0, s46, 29312
    s_add_u32 s84, s46, 0
    buffer_load_dwordx4 v25, s[16:19], s84 offen offset:0 sc1 lds
    buffer_load_dwordx4 v25, s[16:19], s84 offen offset:1024 sc1 lds
    buffer_load_dwordx4 v25, s[16:19], s84 offen offset:2048 sc1 lds
    buffer_load_dwordx4 v25, s[16:19], s84 offen offset:3072 sc1 lds
    s_add_u32 m0, s46, 33408
    s_add_u32 s84, s46, 4096
    buffer_load_dwordx4 v25, s[16:19], s84 offen offset:0 sc1 lds
    buffer_load_dwordx4 v25, s[16:19], s84 offen offset:1024 sc1 lds
    buffer_load_dwordx4 v25, s[16:19], s84 offen offset:2048 sc1 lds
    buffer_load_dwordx4 v25, s[16:19], s84 offen offset:3072 sc1 lds
    s_add_u32 m0, s46, 37504
    s_add_u32 s84, s46, 8192
    buffer_load_dwordx4 v25, s[16:19], s84 offen offset:0 sc1 lds
    buffer_load_dwordx4 v25, s[16:19], s84 offen offset:1024 sc1 lds
    buffer_load_dwordx4 v25, s[16:19], s84 offen offset:2048 sc1 lds
    buffer_load_dwordx4 v25, s[16:19], s84 offen offset:3072 sc1 lds
    s_add_u32 m0, s46, 41600
    s_add_u32 s84, s46, 12288
    buffer_load_dwordx4 v25, s[16:19], s84 offen offset:0 sc1 lds
    v_add_u32 v39, 29312, v25
    s_movk_i32 s84, 600
    buffer_load_dwordx2 v[56:57], v24, s[16:19], 0 offen sc1
    s_branch K2_STUB1
K2_RET1:
    s_branch K2_STUB2
K2_RET2:
    s_branch K2_STUB3
K2_RET3:
    s_waitcnt vmcnt(0)
    s_branch K2_POLL2
K2_POLL:
    buffer_load_dwordx2 v[56:57], v24, s[16:19], 0 offen sc1
    s_waitcnt vmcnt(0)
K2_POLL2:
    v_xor_b32 v36, v56, v23
    v_xor_b32 v37, v57, v22
    v_lshrrev_b32 v36, 24, v36
    v_or_b32 v36, v36, v37
    v_cmp_ne_u32 vcc, 0, v36
    s_and_b64 exec, exec, vcc
    s_cbranch_execz K2_POLLED
    s_sub_u32 s84, s84, 1
    s_cbranch_scc0 K2_POLL
    v_mov_b32 v56, 0
    s_mov_b32 s32, 2
K2_POLLED:
    s_mov_b64 exec, -1
    v_and_b32 v36, 0xfff, v56
    v_bfe_u32 v32, v56, 12, 12
    v_mad_u32_u24 v31, v36, 12, v31
    v_cmp_lt_u32 s[36:37], 24, v32
    s_nop 0
    v_add_u32_dpp v67, v31, v27 row_newbcast:0 row_mask:0xf bank_mask:0xf
    buffer_load_dwordx3 v[64:66], v67, s[12:15], 0 offen sc1
    v_add_u32_dpp v71, v31, v27 row_newbcast:1 row_mask:0xf bank_mask:0xf
    buffer_load_dwordx3 v[68:70], v71, s[12:15], 0 offen sc1
    v_add_u32_dpp v75, v31, v27 row_newbcast:2 row_mask:0xf bank_mask:0xf
    buffer_load_dwordx3 v[72:74], v75, s[12:15], 0 offen sc1
    v_add_u32_dpp v79, v31, v27 row_newbcast:3 row_mask:0xf bank_mask:0xf
    buffer_load_dwordx3 v[76:78], v79, s[12:15], 0 offen sc1
    v_cmp_lt_u32 s[84:85], 16, v32
    v_cmp_lt_u32 s[86:87], 17, v32
    v_cmp_lt_u32 s[88:89], 18, v32
    v_cmp_lt_u32 s[90:91], 19, v32
    v_cmp_lt_u32 s[92:93], 20, v32
    v_cmp_lt_u32 s[94:95], 21, v32
    v_cmp_lt_u32 s[96:97], 22, v32
    v_cmp_lt_u32 s[98:99], 23, v32
    v_add_u32_dpp v83, v31, v27 row_newbcast:4 row_mask:0xf bank_mask:0xf
    v_add_u32_dpp v87, v31, v27 row_newbcast:5 row_mask:0xf bank_mask:0xf
    v_add_u32_dpp v91, v31, v27 row_newbcast:6 row_mask:0xf bank_mask:0xf
    v_add_u32_dpp v95, v31, v27 row_newbcast:7 row_mask:0xf bank_mask:0xf
    v_add_u32_dpp v99, v31, v27 row_newbcast:8 row_mask:0xf bank_mask:0xf
    v_add_u32_dpp v103, v31, v27 row_newbcast:9 row_mask:0xf bank_mask:0xf
    v_add_u32_dpp v107, v31, v27 row_newbcast:10 row_mask:0xf bank_mask:0xf
    v_add_u32_dpp v111, v31, v27 row_newbcast:11 row_mask:0xf bank_mask:0xf
    v_add_u32_dpp v115, v31, v27 row_newbcast:12 row_mask:0xf bank_mask:0xf
    v_add_u32_dpp v119, v31, v27 row_newbcast:13 row_mask:0xf bank_mask:0xf
    v_add_u32_dpp v123, v31, v27 row_newbcast:14 row_mask:0xf bank_mask:0xf
    v_add_u32_dpp v127, v31, v27 row_newbcast:15 row_mask:0xf bank_mask:0xf
    s_mov_b64 exec, s[36:37]
    s_cbranch_execz K2_P1
    buffer_load_dwordx3 v[160:162], v31, s[12:15], 0 offen offset:288 sc1
    buffer_load_dwordx3 v[164:166], v31, s[12:15], 0 offen offset:300 sc1
    buffer_load_dwordx3 v[168:170], v31, s[12:15], 0 offen offset:312 sc1
    buffer_load_dwordx3 v[172:174], v31, s[12:15], 0 offen offset:324 sc1
    v_cmp_lt_u32 vcc, 28, v32
    s_cbranch_vccnz K2_RARE1
    s_branch K2_P1
.p2align 12
K2_STUB1:
    s_branch K2_RET1
K2_P1:
    s_mov_b64 exec, s[84:85]
    buffer_load_dwordx3 v[128:130], v31, s[12:15], 0 offen offset:192 sc1
    s_mov_b64 exec, s[86:87]
    buffer_load_dwordx3 v[132:134], v31, s[12:15], 0 offen offset:204 sc1
    s_mov_b64 exec, s[88:89]
    buffer_load_dwordx3 v[136:138], v31, s[12:15], 0 offen offset:216 sc1
    s_mov_b64 exec, s[90:91]
    buffer_load_dwordx3 v[140:142], v31, s[12:15], 0 offen offset:228 sc1
    s_mov_b64 exec, s[92:93]
    buffer_load_dwordx3 v[144:146], v31, s[12:15], 0 offen offset:240 sc1
    s_mov_b64 exec, s[94:95]
    buffer_load_dwordx3 v[148:150], v31, s[12:15], 0 offen offset:252 sc1
    s_mov_b64 exec, s[96:97]
    buffer_load_dwordx3 v[152:154], v31, s[12:15], 0 offen offset:264 sc1
    s_mov_b64 exec, s[98:99]
    buffer_load_dwordx3 v[156:158], v31, s[12:15], 0 offen offset:276 sc1
    s_mov_b64 exec, -1
    buffer_load_dwordx3 v[80:82], v83, s[12:15], 0 offen sc1
    buffer_load_dwordx3 v[84:86], v87, s[12:15], 0 offen sc1
    buffer_load_dwordx3 v[88:90], v91, s[12:15], 0 offen sc1
    buffer_load_dwordx3 v[92:94], v95, s[12:15], 0 offen sc1
    s_mov_b64 exec, -1
    s_barrier
    ds_read_b128 a[128:131], v39 offset:32768
    v_add_co_u32_dpp v37, vcc, v32, v28 row_newbcast:0 row_mask:0xf bank_mask:0xf
    ds_read_b128 a[132:135], v39 offset:33792
    s_mov_b64 s[52:53], vcc
    ds_read_b128 a[136:139], v39 offset:34816
    v_add_co_u32_dpp v37, vcc, v32, v28 row_newbcast:1 row_mask:0xf bank_mask:0xf
    ds_read_b128 a[140:143], v39 offset:35840
    s_mov_b64 s[54:55], vcc
    ds_read_b128 a[144:147], v39 offset:36864
    v_add_co_u32_dpp v37, vcc, v32, v28 row_newbcast:2 row_mask:0xf bank_mask:0xf
    ds_read_b128 a[148:151], v39 offset:37888
    s_mov_b64 s[56:57], vcc
    ds_read_b128 a[152:155], v39 offset:38912
    v_add_co_u32_dpp v37, vcc, v32, v28 row_newbcast:3 row_mask:0xf bank_mask:0xf
    ds_read_b128 a[156:159], v39 offset:39936
    s_mov_b64 s[58:59], vcc
    ds_read_b128 a[160:163], v39 offset:40960
    v_add_co_u32_dpp v37, vcc, v32, v28 row_newbcast:4 row_mask:0xf bank_mask:0xf
    ds_read_b128 a[164:167], v39 offset:41984
    s_mov_b64 s[60:61], vcc
    ds_read_b128 a[168:171], v39 offset:43008
    v_add_co_u32_dpp v37, vcc, v32, v28 row_newbcast:5 row_mask:0xf bank_mask:0xf
    ds_read_b128 a[172:175], v39 offset:44032
    s_mov_b64 s[62:63], vcc
    ds_read_b128 a[176:179], v39 offset:45056
    v_add_co_u32_dpp v37, vcc, v32, v28 row_newbcast:6 row_mask:0xf bank_mask:0xf
    ds_read_b128 a[180:183], v39 offset:46080
    s_mov_b64 s[64:65], vcc
    ds_read_b128 a[184:187], v39 offset:47104
    v_add_co_u32_dpp v37, vcc, v32, v28 row_newbcast:7 row_mask:0xf bank_mask:0xf
    ds_read_b128 a[188:191], v39 offset:48128
    s_mov_b64 s[66:67], vcc
    ds_read_b128 a[192:195], v39 offset:49152
    v_add_co_u32_dpp v37, vcc, v32, v28 row_newbcast:8 row_mask:0xf bank_mask:0xf
    ds_read_b128 a[196:199], v39 offset:50176
    s_mov_b64 s[68:69], vcc
    ds_read_b128 a[200:203], v39 offset:51200
    v_add_co_u32_dpp v37, vcc, v32, v28 row_newbcast:9 row_mask:0xf bank_mask:0xf
    s_mov_b64 s[70:71], vcc
    v_add_co_u32_dpp v37, vcc, v32, v28 row_newbcast:10 row_mask:0xf bank_mask:0xf
    s_mov_b64 s[72:73], vcc
    v_add_co_u32_dpp v37, vcc, v32, v28 row_newbcast:11 row_mask:0xf bank_mask:0xf
    s_mov_b64 s[74:75], vcc
    v_add_co_u32_dpp v37, vcc, v32, v28 row_newbcast:12 row_mask:0xf bank_mask:0xf
    s_mov_b64 s[76:77], vcc
    v_add_co_u32_dpp v37, vcc, v32, v28 row_newbcast:13 row_mask:0xf bank_mask:0xf
    s_mov_b64 s[78:79], vcc
    v_add_co_u32_dpp v37, vcc, v32, v28 row_newbcast:14 row_mask:0xf bank_mask:0xf
    s_mov_b64 s[80:81], vcc
    v_add_co_u32_dpp v37, vcc, v32, v28 row_newbcast:15 row_mask:0xf bank_mask:0xf
    s_mov_b64 s[82:83], vcc
    s_waitcnt lgkmcnt(0)
    s_barrier
    s_waitcnt vmcnt(15)
    s_mov_b64 exec, s[52:53]
    v_and_b32 v67, s41, v66
    ds_add_rtn_u32 v67, v67, v33
    s_mov_b64 exec, s[68:69]
    buffer_load_dwordx3 v[96:98], v99, s[12:15], 0 offen sc1
    s_waitcnt vmcnt(15)
    s_mov_b64 exec, s[54:55]
    v_and_b32 v71, s41, v70
    ds_add_rtn_u32 v71, v71, v33
    s_mov_b64 exec, s[70:71]
    buffer_load_dwordx3 v[100:102], v103, s[12:15], 0 offen sc1
    s_waitcnt vmcnt(15)
    s_mov_b64 exec, s[56:57]
    v_and_b32 v75, s41, v74
    ds_add_rtn_u32 v75, v75, v33
    s_mov_b64 exec, s[72:73]
    buffer_load_dwordx3 v[104:106], v107, s[12:15], 0 offen sc1
    s_waitcnt vmcnt(15)
    s_mov_b64 exec, s[58:59]
    v_and_b32 v79, s41, v78
    ds_add_rtn_u32 v79, v79, v33
    s_mov_b64 exec, s[74:75]
    buffer_load_dwordx3 v[108:110], v111, s[12:15], 0 offen sc1
    s_waitcnt vmcnt(15)
    s_mov_b64 exec, s[84:85]
    v_and_b32 v131, s41, v130
    ds_add_rtn_u32 v131, v131, v33
    s_mov_b64 exec, s[76:77]
    buffer_load_dwordx3 v[112:114], v115, s[12:15], 0 offen sc1
    s_waitcnt lgkmcnt(4)
    s_mov_b64 exec, s[52:53]
    ds_write2_b32 v67, v64, v65 offset0:0 offset1:1
    ds_write_b32 v67, v66 offset:8
    s_waitcnt vmcnt(15)
    s_mov_b64 exec, s[86:87]
    v_and_b32 v135, s41, v134
    ds_add_rtn_u32 v135, v135, v33
    s_mov_b64 exec, s[78:79]
    buffer_load_dwordx3 v[116:118], v119, s[12:15], 0 offen sc1
    s_waitcnt lgkmcnt(6)
    s_mov_b64 exec, s[54:55]
    ds_write2_b32 v71, v68, v69 offset0:0 offset1:1
    ds_write_b32 v71, v70 offset:8
    s_waitcnt vmcnt(15)
    s_mov_b64 exec, s[88:89]
    v_and_b32 v139, s41, v138
    ds_add_rtn_u32 v139, v139, v33
    s_mov_b64 exec, s[80:81]
    buffer_load_dwordx3 v[120:122], v123, s[12:15], 0 offen sc1
    s_waitcnt lgkmcnt(8)
    s_mov_b64 exec, s[56:57]
    ds_write2_b32 v75, v72, v73 offset0:0 offset1:1
    ds_write_b32 v75, v74 offset:8
    s_waitcnt vmcnt(15)
    s_mov_b64 exec, s[90:91]
    v_and_b32 v143, s41, v142
    ds_add_rtn_u32 v143, v143, v33
    s_mov_b64 exec, s[82:83]
    buffer_load_dwordx3 v[124:126], v127, s[12:15], 0 offen sc1
    s_waitcnt lgkmcnt(10)
    s_mov_b64 exec, s[58:59]
    ds_write2_b32 v79, v76, v77 offset0:0 offset1:1
    ds_write_b32 v79, v78 offset:8
    s_waitcnt vmcnt(15)
    s_mov_b64 exec, s[92:93]
    v_and_b32 v147, s41, v146
    ds_add_rtn_u32 v147, v147, v33
    s_waitcnt lgkmcnt(12)
    s_mov_b64 exec, s[84:85]
    ds_write2_b32 v131, v128, v129 offset0:0 offset1:1
    ds_write_b32 v131, v130 offset:8
    s_waitcnt vmcnt(14)
    s_mov_b64 exec, s[94:95]
    v_and_b32 v151, s41, v150
    ds_add_rtn_u32 v151, v151, v33
    s_waitcnt lgkmcnt(12)
    s_mov_b64 exec, s[86:87]
    ds_write2_b32 v135, v132, v133 offset0:0 offset1:1
    ds_write_b32 v135, v134 offset:8
    s_waitcnt vmcnt(13)
    s_mov_b64 exec, s[96:97]
    v_and_b32 v155, s41, v154
    ds_add_rtn_u32 v155, v155, v33
    s_waitcnt lgkmcnt(12)
    s_mov_b64 exec, s[88:89]
    ds_write2_b32 v139, v136, v137 offset0:0 offset1:1
    ds_write_b32 v139, v138 offset:8
    s_waitcnt vmcnt(12)
    s_mov_b64 exec, s[98:99]
    v_and_b32 v159, s41, v158
    ds_add_rtn_u32 v159, v159, v33
    s_waitcnt lgkmcnt(12)
    s_mov_b64 exec, s[90:91]
    ds_write2_b32 v143, v140, v141 offset0:0 offset1:1
    ds_write_b32 v143, v142 offset:8
    s_waitcnt vmcnt(11)
    s_mov_b64 exec, s[60:61]
    v_and_b32 v83, s41, v82
    ds_add_rtn_u32 v83, v83, v33
    s_waitcnt lgkmcnt(12)
    s_mov_b64 exec, s[92:93]
    ds_write2_b32 v147, v144, v145 offset0:0 offset1:1
    ds_write_b32 v147, v146 offset:8
    s_waitcnt vmcnt(10)
    s_mov_b64 exec, s[62:63]
    v_and_b32 v87, s41, v86
    ds_add_rtn_u32 v87, v87, v33
    s_waitcnt lgkmcnt(12)
    s_mov_b64 exec, s[94:95]
    ds_write2_b32 v151, v148, v149 offset0:0 offset1:1
    ds_write_b32 v151, v150 offset:8
    s_waitcnt vmcnt(9)
    s_mov_b64 exec, s[64:65]
    v_and_b32 v91, s41, v90
    ds_add_rtn_u32 v91, v91, v33
    s_waitcnt lgkmcnt(12)
    s_mov_b64 exec, s[96:97]
    ds_write2_b32 v155, v152, v153 offset0:0 offset1:1
    ds_write_b32 v155, v154 offset:8
    s_waitcnt vmcnt(8)
    s_mov_b64 exec, s[66:67]
    v_and_b32 v95, s41, v94
    ds_add_rtn_u32 v95, v95, v33
    s_waitcnt lgkmcnt(12)
    s_mov_b64 exec, s[98:99]
    ds_write2_b32 v159, v156, v157 offset0:0 offset1:1
    ds_write_b32 v159, v158 offset:8
    s_mov_b64 exec, s[36:37]
    s_cbranch_execz K2_P3
    v_cmp_lt_u32 s[84:85], 24, v32
    v_cmp_lt_u32 s[86:87], 25, v32
    v_cmp_lt_u32 s[88:89], 26, v32
    v_cmp_lt_u32 s[90:91], 27, v32
    s_mov_b64 exec, s[84:85]
    v_and_b32 v163, s41, v162
    ds_add_rtn_u32 v163, v163, v33
    s_mov_b64 exec, s[86:87]
    v_and_b32 v167, s41, v166
    ds_add_rtn_u32 v167, v167, v33
    s_mov_b64 exec, s[88:89]
    v_and_b32 v171, s41, v170
    ds_add_rtn_u32 v171, v171, v33
    s_mov_b64 exec, s[90:91]
    v_and_b32 v175, s41, v174
    ds_add_rtn_u32 v175, v175, v33
    s_waitcnt lgkmcnt(0)
    s_mov_b64 exec, s[84:85]
    ds_write2_b32 v163, v160, v161 offset0:0 offset1:1
    ds_write_b32 v163, v162 offset:8
    s_mov_b64 exec, s[86:87]
    ds_write2_b32 v167, v164, v165 offset0:0 offset1:1
    ds_write_b32 v167, v166 offset:8
    s_mov_b64 exec, s[88:89]
    ds_write2_b32 v171, v168, v169 offset0:0 offset1:1
    ds_write_b32 v171, v170 offset:8
    s_mov_b64 exec, s[90:91]
    ds_write2_b32 v175, v172, v173 offset0:0 offset1:1
    ds_write_b32 v175, v174 offset:8
    v_cmp_lt_u32 vcc, 28, v32
    s_cbranch_vccnz K2_RARE2
K2_P3:
    s_waitcnt vmcnt(7)
    s_mov_b64 exec, s[68:69]
    v_and_b32 v99, s41, v98
    ds_add_rtn_u32 v99, v99, v33
    s_waitcnt lgkmcnt(12)
    s_mov_b64 exec, s[60:61]
    ds_write2_b32 v83, v80, v81 offset0:0 offset1:1
    ds_write_b32 v83, v82 offset:8
    s_waitcnt vmcnt(6)
    s_mov_b64 exec, s[70:71]
    v_and_b32 v103, s41, v102
    ds_add_rtn_u32 v103, v103, v33
    s_waitcnt lgkmcnt(12)
    s_mov_b64 exec, s[62:63]
    ds_write2_b32 v87, v84, v85 offset0:0 offset1:1
    ds_write_b32 v87, v86 offset:8
    s_waitcnt vmcnt(5)
    s_mov_b64 exec, s[72:73]
    v_and_b32 v107, s41, v106
    ds_add_rtn_u32 v107, v107, v33
    s_waitcnt lgkmcnt(12)
    s_mov_b64 exec, s[64:65]
    ds_write2_b32 v91, v88, v89 offset0:0 offset1:1
    ds_write_b32 v91, v90 offset:8
    s_waitcnt vmcnt(4)
    s_mov_b64 exec, s[74:75]
    v_and_b32 v111, s41, v110
    ds_add_rtn_u32 v111, v111, v33
    s_waitcnt lgkmcnt(12)
    s_mov_b64 exec, s[66:67]
    ds_write2_b32 v95, v92, v93 offset0:0 offset1:1
    ds_write_b32 v95, v94 offset:8
    s_waitcnt vmcnt(3)
    s_mov_b64 exec, s[76:77]
    v_and_b32 v115, s41, v114
    ds_add_rtn_u32 v115, v115, v33
    s_add_u32 m0, s33, 4224
    s_mov_b64 exec, -1
    buffer_load_dwordx4 v34, s[4:7], s39 offen offset:0 lds
    buffer_load_dwordx4 v34, s[4:7], s39 offen offset:1024 lds
    s_waitcnt lgkmcnt(12)
    s_mov_b64 exec, s[68:69]
    ds_write2_b32 v99, v96, v97 offset0:0 offset1:1
    ds_write_b32 v99, v98 offset:8
    s_waitcnt vmcnt(4)
    s_mov_b64 exec, s[78:79]
    v_and_b32 v119, s41, v118
    ds_add_rtn_u32 v119, v119, v33
    s_mov_b64 exec, -1
    buffer_load_dwordx4 v34, s[4:7], s39 offen offset:2048 lds
    buffer_load_dwordx4 v34, s[4:7], s39 offen offset:3072 lds
    s_waitcnt lgkmcnt(12)
    s_mov_b64 exec, s[70:71]
    ds_write2_b32 v103, v100, v101 offset0:0 offset1:1
    ds_write_b32 v103, v102 offset:8
    s_waitcnt vmcnt(5)
    s_mov_b64 exec, s[80:81]
    v_and_b32 v123, s41, v122
    ds_add_rtn_u32 v123, v123, v33
    s_add_u32 m0, s33, 8320
    s_add_u32 s39, s39, 4096
    s_mov_b64 exec, -1
    buffer_load_dwordx4 v34, s[4:7], s39 offen offset:0 lds
    buffer_load_dwordx4 v34, s[4:7], s39 offen offset:1024 lds
    s_waitcnt lgkmcnt(12)
    s_mov_b64 exec, s[72:73]
    ds_write2_b32 v107, v104, v105 offset0:0 offset1:1
    ds_write_b32 v107, v106 offset:8
    s_waitcnt vmcnt(6)
    s_mov_b64 exec, s[82:83]
    v_and_b32 v127, s41, v126
    ds_add_rtn_u32 v127, v127, v33
    s_mov_b32 exec_lo, -1
    s_mov_b32 exec_hi, 0
    buffer_load_dwordx4 v34, s[4:7], s39 offen offset:2048 lds
    s_mov_b64 exec, -1
    s_waitcnt lgkmcnt(12)
    s_mov_b64 exec, s[74:75]
    ds_write2_b32 v111, v108, v109 offset0:0 offset1:1
    ds_write_b32 v111, v110 offset:8
    s_waitcnt lgkmcnt(11)
    s_mov_b64 exec, s[76:77]
    ds_write2_b32 v115, v112, v113 offset0:0 offset1:1
    ds_write_b32 v115, v114 offset:8
    s_waitcnt lgkmcnt(10)
    s_mov_b64 exec, s[78:79]
    ds_write2_b32 v119, v116, v117 offset0:0 offset1:1
    ds_write_b32 v119, v118 offset:8
    s_waitcnt lgkmcnt(9)
    s_mov_b64 exec, s[80:81]
    ds_write2_b32 v123, v120, v121 offset0:0 offset1:1
    ds_write_b32 v123, v122 offset:8
    s_waitcnt lgkmcnt(8)
    s_mov_b64 exec, s[82:83]
    ds_write2_b32 v127, v124, v125 offset0:0 offset1:1
    ds_write_b32 v127, v126 offset:8
    s_mov_b64 exec, -1
K2_P2:
    s_waitcnt lgkmcnt(0)
    s_barrier
    ds_read_b32 v40, v18 offset:0
    ds_read_b32 v58, v17 offset:8
    v_mov_b32 v43, 1
    v_cmp_gt_u32 vcc, 196, v16
    v_lshlrev_b32 v36, 2, v13
    s_mov_b64 s[30:31], vcc
    s_waitcnt lgkmcnt(1)
    v_sub_u32 v40, v40, v17
    v_cmp_lt_u32 vcc, 516, v40
    v_min_u32 v40, 756, v40
    v_mul_u32_u24 v40, 5462, v40
    s_or_b64 s[34:35], s[34:35], vcc
    v_lshrrev_b32 v40, 16, v40
    v_lshlrev_b32 v37, 2, v40
    s_mov_b64 exec, s[30:31]
    ds_add_rtn_u32 v41, v37, v43 offset:1024
    s_cmp_lg_u64 s[34:35], 0
    s_addc_u32 s32, s32, 0
    s_mov_b64 exec, 1
    v_mov_b32 v39, s32
    ds_or_b32 v20, v39 offset:1280
    s_mov_b64 exec, -1
    v_add_u32 v59, 1, v40
    v_lshrrev_b32 v59, 1, v59
    v_mad_u32_u24 v59, v59, 12, v17
    ds_read_b32 v59, v59 offset:8
    v_lshl_or_b32 v40, v40, 8, v16
    s_waitcnt lgkmcnt(1)
    v_bfi_b32 v58, s41, v40, v58
    s_barrier
    ds_read_b32 v42, v36 offset:1024
    ds_read_b32 v38, v20 offset:1280
    s_waitcnt lgkmcnt(1)
    s_nop 1
    v_add_u32_dpp v42, v42, v42 row_shr:1 row_mask:0xf bank_mask:0xf
    s_nop 1
    v_add_u32_dpp v42, v42, v42 row_shr:2 row_mask:0xf bank_mask:0xf
    s_nop 1
    v_add_u32_dpp v42, v42, v42 row_shr:4 row_mask:0xf bank_mask:0xf
    s_nop 1
    v_add_u32_dpp v42, v42, v42 row_shr:8 row_mask:0xf bank_mask:0xf
    s_nop 1
    v_add_u32_dpp v42, v42, v42 row_bcast:15 row_mask:0xa bank_mask:0xf
    s_nop 1
    v_add_u32_dpp v42, v42, v42 row_bcast:31 row_mask:0xc bank_mask:0xf
    v_sub_u32 v42, 196, v42
    ds_bpermute_b32 v42, v37, v42
    s_waitcnt lgkmcnt(1)
    v_readfirstlane_b32 s27, v38
    s_mul_i32 s28, s21, 25088
    s_lshl_b32 s25, s20, 8
    s_cmp_ge_u32 s27, 2
    s_cbranch_scc1 K2_SLOW
    s_mov_b64 exec, 1
    buffer_store_dword v22, v20, s[16:19], s40 offen
    s_mov_b64 exec, s[30:31]
    s_cmp_lg_u32 s27, 0
    s_cbranch_scc1 K2_SLOW
    s_waitcnt lgkmcnt(0)
    v_add_lshl_u32 v42, v42, v41, 3
    ds_write_b64 v42, v[58:59] offset:1536
    s_mov_b64 exec, -1
    s_movk_i32 s46, 516
    v_mov_b32 v39, 62080
    v_lshrrev_b32 v38, 4, v11
    v_add_u32 v36, s25, v29
    v_cmp_ne_u32 vcc, 0, v47
    s_waitcnt lgkmcnt(0)
    s_barrier
    ds_read_b64 v[56:57], v44 offset:1536
    ds_read_b32 v60, v50 offset:1536
    v_mov_b32 v244, 0x3f80
    v_mov_b32 v245, 0
    v_mov_b32 v246, 1.0
    v_mov_b32 v247, 0
    v_mov_b32 v248, 0
    v_mov_b32 v249, 0x3f80
    v_mov_b32 v250, 0
    v_mov_b32 v251, 1.0
    s_waitcnt lgkmcnt(1)
    v_cndmask_b32 v2, v56, v57, vcc
    v_mad_u32_u16 v3, v2, s22, v11 op_sel:[1,0,0,0]
    buffer_load_dwordx4 a[204:207], v3, s[4:7], 0 offen offset:0
    v_bfe_u32 v57, v56, 8, 8
    v_and_b32 v56, 0xff, v56
    v_add_u32 v58, v57, v45
    v_lshrrev_b32 v58, v46, v58
    v_mad_u32_u24 v7, v56, s46, v39
    v_sub_u32 v57, v57, v58
    v_mad_u32_u24 v7, v57, v47, v7
    ds_read_b32 v6, v7 offset:20
    ds_read_b32 v10, v7 offset:32
    ds_read2_b32 v[0:1], v7 offset0:0 offset1:1
    ds_read2_b32 v[4:5], v7 offset0:3 offset1:4
    ds_read2_b32 v[8:9], v7 offset0:6 offset1:7
    v_and_b32 v57, 7, v56
    v_xor_b32 v57, v57, v38
    v_lshlrev_b32 v57, 4, v57
    v_lshl_add_u32 v57, v56, 7, v57
    v_lshl_or_b32 v14, v58, 16, v57
    v_lshrrev_b32 v12, 16, v14
    s_movk_i32 s24, 0
    v_readlane_b32 s26, v12, 0
    v_readlane_b32 s27, v12, s38
    v_cmp_lt_u32 s[30:31], 0, v12
    s_max_u32 s26, s26, s27
    s_max_u32 s26, s26, 4
    s_sub_u32 s23, s26, 4
    s_sub_u32 s26, s26, 3
    v_sub_u32 v12, s26, v12
    v_accvgpr_write_b32 a252, v14
    v_lshl_add_u32 v56, v56, 7, s28
    v_or_b32 v56, v56, v48
    ds_write_b32 v36, v56 offset:3200
    s_waitcnt lgkmcnt(6)
    buffer_load_dwordx4 a[208:211], v3, s[4:7], 0 offen offset:16
    v_bfe_u32 v61, v60, 8, 8
    v_and_b32 v60, 0xff, v60
    v_add_u32 v62, v61, v51
    v_lshrrev_b32 v62, v52, v62
    v_mad_u32_u24 v63, v60, s46, v39
    v_sub_u32 v61, v61, v62
    v_mad_u32_u24 v63, v61, v53, v63
    v_accvgpr_write_b32 a253, v63
    v_and_b32 v61, 7, v60
    v_xor_b32 v61, v61, v38
    v_lshlrev_b32 v61, 4, v61
    v_lshl_add_u32 v61, v60, 7, v61
    v_lshl_or_b32 v63, v62, 16, v61
    v_accvgpr_write_b32 a254, v63
    v_lshl_add_u32 v60, v60, 7, s28
    v_or_b32 v60, v60, v54
    ds_write_b32 v36, v60 offset:3328
    s_waitcnt vmcnt(3)
    s_barrier
    v_and_b32 v15, 0xffff, v14
    ds_read_b128 a[236:239], v15 offset:4224
    v_xor_b32 v59, 16, v15
    ds_read_b128 a[240:243], v59 offset:4224
    v_xor_b32 v254, 32, v15
    ds_read_b128 a[244:247], v254 offset:4224
    v_xor_b32 v255, 48, v15
    ds_read_b128 a[248:251], v255 offset:4224
    v_mov_b32 v240, v25
    buffer_load_dwordx4 a[212:215], v3, s[4:7], 0 offen offset:32
    s_waitcnt lgkmcnt(0)
    v_mfma_f32_32x32x8_bf16 v[16:31], a[136:137], v[244:245], 0
    ds_read_b128 a[0:3], v240 offset:29312
    ds_read_b128 a[4:7], v240 offset:30336
    v_mfma_f32_32x32x16_bf16 v[16:31], a[140:143], a[236:239], v[16:31]
    ds_read_b128 a[8:11], v240 offset:31360
    ds_read_b128 a[12:15], v240 offset:32384
    v_mfma_f32_32x32x16_bf16 v[16:31], a[144:147], a[240:243], v[16:31]
    ds_read_b128 a[16:19], v240 offset:33408
    ds_read_b128 a[20:23], v240 offset:34432
    v_mfma_f32_32x32x16_bf16 v[16:31], a[148:151], a[244:247], v[16:31]
    ds_read_b128 a[24:27], v240 offset:35456
    ds_read_b128 a[28:31], v240 offset:36480
    v_mfma_f32_32x32x16_bf16 v[16:31], a[152:155], a[248:251], v[16:31]
    buffer_load_dwordx4 a[216:219], v3, s[4:7], 0 offen offset:48
    v_mfma_f32_32x32x8_bf16 v[32:47], a[136:137], v[246:247], 0
    ds_read_b128 a[32:35], v240 offset:37504
    ds_read_b128 a[36:39], v240 offset:38528
    v_mfma_f32_32x32x16_bf16 v[32:47], a[156:159], a[236:239], v[32:47]
    ds_read_b128 a[40:43], v240 offset:39552
    ds_read_b128 a[44:47], v240 offset:40576
    v_mfma_f32_32x32x16_bf16 v[32:47], a[160:163], a[240:243], v[32:47]
    ds_read_b128 a[48:51], v240 offset:41600
    ds_read_b128 a[52:55], v240 offset:42624
    v_mfma_f32_32x32x16_bf16 v[32:47], a[164:167], a[244:247], v[32:47]
    ds_read_b128 a[56:59], v240 offset:43648
    ds_read_b128 a[60:63], v240 offset:44672
    v_mfma_f32_32x32x16_bf16 v[32:47], a[168:171], a[248:251], v[32:47]
    v_mad_u32_u16 v3, v6, s22, v11 op_sel:[1,0,0,0]
    buffer_load_dwordx4 a[220:223], v3, s[4:7], 0 offen offset:0
    v_mfma_f32_32x32x8_bf16 v[48:63], a[136:137], v[248:249], 0
    ds_read_b128 a[64:67], v240 offset:45696
    ds_read_b128 a[68:71], v240 offset:46720
    v_mfma_f32_32x32x16_bf16 v[48:63], a[172:175], a[236:239], v[48:63]
    ds_read_b128 a[72:75], v240 offset:47744
    ds_read_b128 a[76:79], v240 offset:48768
    v_mfma_f32_32x32x16_bf16 v[48:63], a[176:179], a[240:243], v[48:63]
    ds_read_b128 a[80:83], v240 offset:49792
    ds_read_b128 a[84:87], v240 offset:50816
    v_mfma_f32_32x32x16_bf16 v[48:63], a[180:183], a[244:247], v[48:63]
    ds_read_b128 a[88:91], v240 offset:51840
    ds_read_b128 a[92:95], v240 offset:52864
    v_mfma_f32_32x32x16_bf16 v[48:63], a[184:187], a[248:251], v[48:63]
    buffer_load_dwordx4 a[224:227], v3, s[4:7], 0 offen offset:16
    v_mfma_f32_32x32x8_bf16 v[64:79], a[136:137], v[250:251], 0
    ds_read_b128 a[96:99], v240 offset:53888
    ds_read_b128 a[100:103], v240 offset:54912
    v_mfma_f32_32x32x16_bf16 v[64:79], a[188:191], a[236:239], v[64:79]
    ds_read_b128 a[104:107], v240 offset:55936
    ds_read_b128 a[108:111], v240 offset:56960
    v_mfma_f32_32x32x16_bf16 v[64:79], a[192:195], a[240:243], v[64:79]
    ds_read_b128 a[112:115], v240 offset:57984
    ds_read_b128 a[116:119], v240 offset:59008
    v_mfma_f32_32x32x16_bf16 v[64:79], a[196:199], a[244:247], v[64:79]
    ds_read_b128 a[120:123], v240 offset:60032
    ds_read_b128 a[124:127], v240 offset:61056
    v_mfma_f32_32x32x16_bf16 v[64:79], a[200:203], a[248:251], v[64:79]
    buffer_load_dwordx4 a[228:231], v3, s[4:7], 0 offen offset:32
    buffer_load_dwordx4 a[232:235], v3, s[4:7], 0 offen offset:48
    s_waitcnt lgkmcnt(15)
    v_mfma_f32_32x32x8_bf16 v[80:95], a[128:129], v[0:1], v[16:31]
    v_mad_u32_u16 v3, v10, s22, v11 op_sel:[1,0,0,0]
    s_waitcnt vmcnt(7)
    v_mfma_f32_32x32x16_bf16 v[80:95], a[0:3], a[204:207], v[80:95]
    s_waitcnt vmcnt(6)
    v_mfma_f32_32x32x16_bf16 v[80:95], a[4:7], a[208:211], v[80:95]
    s_waitcnt vmcnt(5)
    v_mfma_f32_32x32x16_bf16 v[80:95], a[8:11], a[212:215], v[80:95]
    s_waitcnt vmcnt(4)
    v_mfma_f32_32x32x16_bf16 v[80:95], a[12:15], a[216:219], v[80:95]
    s_nop 10
.p2align 3
    s_mov_b64 exec, s[30:31]
    v_mfma_f32_32x32x8_bf16 v[96:111], a[130:131], v[0:1], v[32:47]
    v_exp_f32 v144, v80
    buffer_load_dwordx4 a[236:239], v3, s[4:7], 0 offen offset:0
    v_exp_f32 v145, v81
    v_exp_f32 v146, v82
    v_mfma_f32_32x32x16_bf16 v[96:111], a[16:19], a[204:207], v[96:111]
    v_exp_f32 v147, v83
    v_exp_f32 v148, v84
    v_exp_f32 v149, v85
    v_mfma_f32_32x32x16_bf16 v[96:111], a[20:23], a[208:211], v[96:111]
    v_exp_f32 v150, v86
    v_exp_f32 v151, v87
    v_exp_f32 v152, v88
    v_mfma_f32_32x32x16_bf16 v[96:111], a[24:27], a[212:215], v[96:111]
    v_exp_f32 v153, v89
    v_exp_f32 v154, v90
    v_exp_f32 v155, v91
    v_mfma_f32_32x32x16_bf16 v[96:111], a[28:31], a[216:219], v[96:111]
    v_exp_f32 v156, v92
    v_exp_f32 v157, v93
    v_exp_f32 v158, v94
    v_exp_f32_e64 v159, v95
    v_pk_add_f32 v[144:145], v[144:145], 1.0 op_sel_hi:[1,0]
    v_pk_add_f32 v[146:147], v[146:147], 1.0 op_sel_hi:[1,0]
    v_pk_add_f32 v[148:149], v[148:149], 1.0 op_sel_hi:[1,0]
    v_pk_add_f32 v[150:151], v[150:151], 1.0 op_sel_hi:[1,0]
    v_pk_add_f32 v[152:153], v[152:153], 1.0 op_sel_hi:[1,0]
    v_pk_add_f32 v[154:155], v[154:155], 1.0 op_sel_hi:[1,0]
    v_pk_add_f32 v[156:157], v[156:157], 1.0 op_sel_hi:[1,0]
    v_pk_add_f32 v[158:159], v[158:159], 1.0 op_sel_hi:[1,0]
    v_mfma_f32_32x32x8_bf16 v[112:127], a[132:133], v[0:1], v[48:63]
    v_exp_f32 v160, v96
    buffer_load_dwordx4 a[240:243], v3, s[4:7], 0 offen offset:16
    v_exp_f32 v161, v97
    v_exp_f32 v162, v98
    v_mfma_f32_32x32x16_bf16 v[112:127], a[32:35], a[204:207], v[112:127]
    v_exp_f32 v163, v99
    v_exp_f32 v164, v100
    v_exp_f32 v165, v101
    v_mfma_f32_32x32x16_bf16 v[112:127], a[36:39], a[208:211], v[112:127]
    v_exp_f32 v166, v102
    v_exp_f32 v167, v103
    v_exp_f32 v168, v104
    v_mfma_f32_32x32x16_bf16 v[112:127], a[40:43], a[212:215], v[112:127]
    v_exp_f32 v169, v105
    v_exp_f32 v170, v106
    v_exp_f32 v171, v107
    v_mfma_f32_32x32x16_bf16 v[112:127], a[44:47], a[216:219], v[112:127]
    v_exp_f32 v172, v108
    v_exp_f32 v173, v109
    v_exp_f32 v174, v110
    v_exp_f32 v175, v111
    v_pk_add_f32 v[160:161], v[160:161], 1.0 op_sel_hi:[1,0]
    v_pk_add_f32 v[162:163], v[162:163], 1.0 op_sel_hi:[1,0]
    v_pk_add_f32 v[164:165], v[164:165], 1.0 op_sel_hi:[1,0]
    v_pk_add_f32 v[166:167], v[166:167], 1.0 op_sel_hi:[1,0]
    v_pk_add_f32 v[168:169], v[168:169], 1.0 op_sel_hi:[1,0]
    v_pk_add_f32 v[170:171], v[170:171], 1.0 op_sel_hi:[1,0]
    v_pk_add_f32 v[172:173], v[172:173], 1.0 op_sel_hi:[1,0]
    v_pk_add_f32 v[174:175], v[174:175], 1.0 op_sel_hi:[1,0]
    v_mfma_f32_32x32x8_bf16 v[128:143], a[134:135], v[0:1], v[64:79]
    v_exp_f32 v176, v112
    buffer_load_dwordx4 a[244:247], v3, s[4:7], 0 offen offset:32
    v_exp_f32 v177, v113
    v_exp_f32 v178, v114
    v_mfma_f32_32x32x16_bf16 v[128:143], a[48:51], a[204:207], v[128:143]
    v_exp_f32 v179, v115
    v_exp_f32 v180, v116
    v_exp_f32 v181, v117
    v_mfma_f32_32x32x16_bf16 v[128:143], a[52:55], a[208:211], v[128:143]
    v_exp_f32 v182, v118
    v_exp_f32 v183, v119
    v_exp_f32 v184, v120
    v_mfma_f32_32x32x16_bf16 v[128:143], a[56:59], a[212:215], v[128:143]
    v_exp_f32 v185, v121
    v_exp_f32 v186, v122
    v_exp_f32 v187, v123
    v_mfma_f32_32x32x16_bf16 v[128:143], a[60:63], a[216:219], v[128:143]
    v_exp_f32 v188, v124
    v_exp_f32 v189, v125
    v_exp_f32 v190, v126
    v_exp_f32 v191, v127
    ds_read_b96 v[0:2], v7 offset:36
    v_pk_add_f32 v[176:177], v[176:177], 1.0 op_sel_hi:[1,0]
    v_pk_add_f32 v[178:179], v[178:179], 1.0 op_sel_hi:[1,0]
    v_pk_add_f32 v[180:181], v[180:181], 1.0 op_sel_hi:[1,0]
    v_pk_add_f32 v[182:183], v[182:183], 1.0 op_sel_hi:[1,0]
    v_pk_add_f32 v[184:185], v[184:185], 1.0 op_sel_hi:[1,0]
    v_pk_add_f32 v[186:187], v[186:187], 1.0 op_sel_hi:[1,0]
    v_pk_add_f32 v[188:189], v[188:189], 1.0 op_sel_hi:[1,0]
    v_pk_add_f32 v[190:191], v[190:191], 1.0 op_sel_hi:[1,0]
    v_mfma_f32_32x32x8_bf16 v[208:223], a[128:129], v[4:5], v[16:31]
    v_exp_f32 v192, v128
    s_waitcnt vmcnt(3)
    buffer_load_dwordx4 a[248:251], v3, s[4:7], 0 offen offset:48
    v_exp_f32 v193, v129
    v_exp_f32 v194, v130
    v_mfma_f32_32x32x16_bf16 v[208:223], a[0:3], a[220:223], v[208:223]
    v_exp_f32 v195, v131
    v_exp_f32 v196, v132
    v_exp_f32 v197, v133
    v_mfma_f32_32x32x16_bf16 v[208:223], a[4:7], a[224:227], v[208:223]
    v_exp_f32 v198, v134
    v_exp_f32 v199, v135
    v_exp_f32 v200, v136
    v_mfma_f32_32x32x16_bf16 v[208:223], a[8:11], a[228:231], v[208:223]
    v_exp_f32 v201, v137
    v_exp_f32 v202, v138
    v_exp_f32 v203, v139
    v_mfma_f32_32x32x16_bf16 v[208:223], a[12:15], a[232:235], v[208:223]
    v_exp_f32 v204, v140
    v_exp_f32 v205, v141
    v_exp_f32 v206, v142
    v_exp_f32 v207, v143
    s_waitcnt lgkmcnt(0)
    v_mad_u32_u16 v3, v2, s22, v11 op_sel:[1,0,0,0]
    v_pk_add_f32 v[192:193], v[192:193], 1.0 op_sel_hi:[1,0]
    v_pk_add_f32 v[194:195], v[194:195], 1.0 op_sel_hi:[1,0]
    v_pk_add_f32 v[196:197], v[196:197], 1.0 op_sel_hi:[1,0]
    v_pk_add_f32 v[198:199], v[198:199], 1.0 op_sel_hi:[1,0]
    v_pk_add_f32 v[200:201], v[200:201], 1.0 op_sel_hi:[1,0]
    v_pk_add_f32 v[202:203], v[202:203], 1.0 op_sel_hi:[1,0]
    v_pk_add_f32 v[204:205], v[204:205], 1.0 op_sel_hi:[1,0]
    v_pk_add_f32 v[206:207], v[206:207], 1.0 op_sel_hi:[1,0]
    s_branch K2_L1
.p2align 12
K2_STUB2:
    s_branch K2_RET2
.p2align 3
K2_L1:
    v_mfma_f32_32x32x8_bf16 v[224:239], a[130:131], v[4:5], v[32:47]
    v_exp_f32 v240, v208
    buffer_load_dwordx4 a[204:207], v3, s[4:7], 0 offen offset:0
    v_exp_f32 v241, v209
    v_exp_f32 v242, v210
    v_mfma_f32_32x32x16_bf16 v[224:239], a[16:19], a[220:223], v[224:239]
    v_exp_f32 v243, v211
    v_exp_f32 v244, v212
    v_exp_f32 v245, v213
    v_mfma_f32_32x32x16_bf16 v[224:239], a[20:23], a[224:227], v[224:239]
    v_exp_f32 v246, v214
    v_exp_f32 v247, v215
    v_exp_f32 v248, v216
    v_mfma_f32_32x32x16_bf16 v[224:239], a[24:27], a[228:231], v[224:239]
    v_exp_f32 v249, v217
    v_exp_f32 v250, v218
    v_exp_f32 v251, v219
    v_mfma_f32_32x32x16_bf16 v[224:239], a[28:31], a[232:235], v[224:239]
    v_exp_f32 v252, v220
    v_exp_f32 v253, v221
    v_exp_f32 v254, v222
    v_exp_f32_e64 v255, v223
    v_cmpx_gt_i32 vcc, s23, v12
    v_pk_fma_f32 v[80:81], v[80:81], v[240:241], v[80:81]
    v_pk_fma_f32 v[82:83], v[82:83], v[242:243], v[82:83]
    v_pk_fma_f32 v[84:85], v[84:85], v[244:245], v[84:85]
    v_pk_fma_f32 v[86:87], v[86:87], v[246:247], v[86:87]
    v_pk_fma_f32 v[88:89], v[88:89], v[248:249], v[88:89]
    v_pk_fma_f32 v[90:91], v[90:91], v[250:251], v[90:91]
    v_pk_fma_f32 v[92:93], v[92:93], v[252:253], v[92:93]
    v_pk_fma_f32 v[94:95], v[94:95], v[254:255], v[94:95]
    v_pk_fma_f32 v[80:81], v[208:209], v[144:145], v[80:81]
    v_pk_fma_f32 v[82:83], v[210:211], v[146:147], v[82:83]
    v_pk_fma_f32 v[84:85], v[212:213], v[148:149], v[84:85]
    v_pk_fma_f32 v[86:87], v[214:215], v[150:151], v[86:87]
    v_pk_fma_f32 v[88:89], v[216:217], v[152:153], v[88:89]
    v_pk_fma_f32 v[90:91], v[218:219], v[154:155], v[90:91]
    v_pk_fma_f32 v[92:93], v[220:221], v[156:157], v[92:93]
    v_pk_fma_f32 v[94:95], v[222:223], v[158:159], v[94:95]
    v_pk_fma_f32 v[144:145], v[144:145], v[240:241], v[144:145]
    v_pk_fma_f32 v[146:147], v[146:147], v[242:243], v[146:147]
    v_pk_fma_f32 v[148:149], v[148:149], v[244:245], v[148:149]
    v_pk_fma_f32 v[150:151], v[150:151], v[246:247], v[150:151]
    v_pk_fma_f32 v[152:153], v[152:153], v[248:249], v[152:153]
    v_pk_fma_f32 v[154:155], v[154:155], v[250:251], v[154:155]
    v_pk_fma_f32 v[156:157], v[156:157], v[252:253], v[156:157]
    v_pk_fma_f32 v[158:159], v[158:159], v[254:255], v[158:159]
    v_mfma_f32_32x32x8_bf16 v[208:223], a[132:133], v[4:5], v[48:63]
    v_exp_f32 v240, v224
    buffer_load_dwordx4 a[208:211], v3, s[4:7], 0 offen offset:16
    v_exp_f32 v241, v225
    v_exp_f32 v242, v226
    v_mfma_f32_32x32x16_bf16 v[208:223], a[32:35], a[220:223], v[208:223]
    v_exp_f32 v243, v227
    v_exp_f32 v244, v228
    v_exp_f32 v245, v229
    v_mfma_f32_32x32x16_bf16 v[208:223], a[36:39], a[224:227], v[208:223]
    v_exp_f32 v246, v230
    v_exp_f32 v247, v231
    v_exp_f32 v248, v232
    v_mfma_f32_32x32x16_bf16 v[208:223], a[40:43], a[228:231], v[208:223]
    v_exp_f32 v249, v233
    v_exp_f32 v250, v234
    v_exp_f32 v251, v235
    v_mfma_f32_32x32x16_bf16 v[208:223], a[44:47], a[232:235], v[208:223]
    v_exp_f32 v252, v236
    v_exp_f32 v253, v237
    v_exp_f32 v254, v238
    v_exp_f32_e64 v255, v239
    s_sub_u32 s23, s23, 1
    v_pk_fma_f32 v[96:97], v[96:97], v[240:241], v[96:97]
    v_pk_fma_f32 v[98:99], v[98:99], v[242:243], v[98:99]
    v_pk_fma_f32 v[100:101], v[100:101], v[244:245], v[100:101]
    v_pk_fma_f32 v[102:103], v[102:103], v[246:247], v[102:103]
    v_pk_fma_f32 v[104:105], v[104:105], v[248:249], v[104:105]
    v_pk_fma_f32 v[106:107], v[106:107], v[250:251], v[106:107]
    v_pk_fma_f32 v[108:109], v[108:109], v[252:253], v[108:109]
    v_pk_fma_f32 v[110:111], v[110:111], v[254:255], v[110:111]
    v_pk_fma_f32 v[96:97], v[224:225], v[160:161], v[96:97]
    v_pk_fma_f32 v[98:99], v[226:227], v[162:163], v[98:99]
    v_pk_fma_f32 v[100:101], v[228:229], v[164:165], v[100:101]
    v_pk_fma_f32 v[102:103], v[230:231], v[166:167], v[102:103]
    v_pk_fma_f32 v[104:105], v[232:233], v[168:169], v[104:105]
    v_pk_fma_f32 v[106:107], v[234:235], v[170:171], v[106:107]
    v_pk_fma_f32 v[108:109], v[236:237], v[172:173], v[108:109]
    v_pk_fma_f32 v[110:111], v[238:239], v[174:175], v[110:111]
    v_pk_fma_f32 v[160:161], v[160:161], v[240:241], v[160:161]
    v_pk_fma_f32 v[162:163], v[162:163], v[242:243], v[162:163]
    v_pk_fma_f32 v[164:165], v[164:165], v[244:245], v[164:165]
    v_pk_fma_f32 v[166:167], v[166:167], v[246:247], v[166:167]
    v_pk_fma_f32 v[168:169], v[168:169], v[248:249], v[168:169]
    v_pk_fma_f32 v[170:171], v[170:171], v[250:251], v[170:171]
    v_pk_fma_f32 v[172:173], v[172:173], v[252:253], v[172:173]
    v_pk_fma_f32 v[174:175], v[174:175], v[254:255], v[174:175]
    v_mfma_f32_32x32x8_bf16 v[224:239], a[134:135], v[4:5], v[64:79]
    v_exp_f32 v240, v208
    buffer_load_dwordx4 a[212:215], v3, s[4:7], 0 offen offset:32
    v_exp_f32 v241, v209
    v_exp_f32 v242, v210
    v_mfma_f32_32x32x16_bf16 v[224:239], a[48:51], a[220:223], v[224:239]
    v_exp_f32 v243, v211
    v_exp_f32 v244, v212
    v_exp_f32 v245, v213
    v_mfma_f32_32x32x16_bf16 v[224:239], a[52:55], a[224:227], v[224:239]
    v_exp_f32 v246, v214
    v_exp_f32 v247, v215
    v_exp_f32 v248, v216
    v_mfma_f32_32x32x16_bf16 v[224:239], a[56:59], a[228:231], v[224:239]
    v_exp_f32 v249, v217
    v_exp_f32 v250, v218
    v_exp_f32 v251, v219
    v_mfma_f32_32x32x16_bf16 v[224:239], a[60:63], a[232:235], v[224:239]
    v_exp_f32 v252, v220
    v_exp_f32 v253, v221
    v_exp_f32 v254, v222
    v_exp_f32 v255, v223
    ds_read_b96 v[4:6], v7 offset:48
    v_pk_fma_f32 v[112:113], v[112:113], v[240:241], v[112:113]
    v_pk_fma_f32 v[114:115], v[114:115], v[242:243], v[114:115]
    v_pk_fma_f32 v[116:117], v[116:117], v[244:245], v[116:117]
    v_pk_fma_f32 v[118:119], v[118:119], v[246:247], v[118:119]
    v_pk_fma_f32 v[120:121], v[120:121], v[248:249], v[120:121]
    v_pk_fma_f32 v[122:123], v[122:123], v[250:251], v[122:123]
    v_pk_fma_f32 v[124:125], v[124:125], v[252:253], v[124:125]
    v_pk_fma_f32 v[126:127], v[126:127], v[254:255], v[126:127]
    v_pk_fma_f32 v[112:113], v[208:209], v[176:177], v[112:113]
    v_pk_fma_f32 v[114:115], v[210:211], v[178:179], v[114:115]
    v_pk_fma_f32 v[116:117], v[212:213], v[180:181], v[116:117]
    v_pk_fma_f32 v[118:119], v[214:215], v[182:183], v[118:119]
    v_pk_fma_f32 v[120:121], v[216:217], v[184:185], v[120:121]
    v_pk_fma_f32 v[122:123], v[218:219], v[186:187], v[122:123]
    v_pk_fma_f32 v[124:125], v[220:221], v[188:189], v[124:125]
    v_pk_fma_f32 v[126:127], v[222:223], v[190:191], v[126:127]
    v_pk_fma_f32 v[176:177], v[176:177], v[240:241], v[176:177]
    v_pk_fma_f32 v[178:179], v[178:179], v[242:243], v[178:179]
    v_pk_fma_f32 v[180:181], v[180:181], v[244:245], v[180:181]
    v_pk_fma_f32 v[182:183], v[182:183], v[246:247], v[182:183]
    v_pk_fma_f32 v[184:185], v[184:185], v[248:249], v[184:185]
    v_pk_fma_f32 v[186:187], v[186:187], v[250:251], v[186:187]
    v_pk_fma_f32 v[188:189], v[188:189], v[252:253], v[188:189]
    v_pk_fma_f32 v[190:191], v[190:191], v[254:255], v[190:191]
    v_mfma_f32_32x32x8_bf16 v[208:223], a[128:129], v[8:9], v[16:31]
    v_exp_f32 v240, v224
    s_waitcnt vmcnt(3)
    buffer_load_dwordx4 a[216:219], v3, s[4:7], 0 offen offset:48
    v_exp_f32 v241, v225
    v_exp_f32 v242, v226
    v_mfma_f32_32x32x16_bf16 v[208:223], a[0:3], a[236:239], v[208:223]
    v_exp_f32 v243, v227
    v_exp_f32 v244, v228
    v_exp_f32 v245, v229
    v_mfma_f32_32x32x16_bf16 v[208:223], a[4:7], a[240:243], v[208:223]
    v_exp_f32 v246, v230
    v_exp_f32 v247, v231
    v_exp_f32 v248, v232
    v_mfma_f32_32x32x16_bf16 v[208:223], a[8:11], a[244:247], v[208:223]
    v_exp_f32 v249, v233
    v_exp_f32 v250, v234
    v_exp_f32 v251, v235
    v_mfma_f32_32x32x16_bf16 v[208:223], a[12:15], a[248:251], v[208:223]
    v_exp_f32 v252, v236
    v_exp_f32 v253, v237
    v_exp_f32 v254, v238
    v_exp_f32 v255, v239
    s_waitcnt lgkmcnt(0)
    v_mad_u32_u16 v3, v6, s22, v11 op_sel:[1,0,0,0]
    v_pk_fma_f32 v[128:129], v[128:129], v[240:241], v[128:129]
    v_pk_fma_f32 v[130:131], v[130:131], v[242:243], v[130:131]
    v_pk_fma_f32 v[132:133], v[132:133], v[244:245], v[132:133]
    v_pk_fma_f32 v[134:135], v[134:135], v[246:247], v[134:135]
    v_pk_fma_f32 v[136:137], v[136:137], v[248:249], v[136:137]
    v_pk_fma_f32 v[138:139], v[138:139], v[250:251], v[138:139]
    v_pk_fma_f32 v[140:141], v[140:141], v[252:253], v[140:141]
    v_pk_fma_f32 v[142:143], v[142:143], v[254:255], v[142:143]
    v_pk_fma_f32 v[128:129], v[224:225], v[192:193], v[128:129]
    v_pk_fma_f32 v[130:131], v[226:227], v[194:195], v[130:131]
    v_pk_fma_f32 v[132:133], v[228:229], v[196:197], v[132:133]
    v_pk_fma_f32 v[134:135], v[230:231], v[198:199], v[134:135]
    v_pk_fma_f32 v[136:137], v[232:233], v[200:201], v[136:137]
    v_pk_fma_f32 v[138:139], v[234:235], v[202:203], v[138:139]
    v_pk_fma_f32 v[140:141], v[236:237], v[204:205], v[140:141]
    v_pk_fma_f32 v[142:143], v[238:239], v[206:207], v[142:143]
    v_pk_fma_f32 v[192:193], v[192:193], v[240:241], v[192:193]
    v_pk_fma_f32 v[194:195], v[194:195], v[242:243], v[194:195]
    v_pk_fma_f32 v[196:197], v[196:197], v[244:245], v[196:197]
    v_pk_fma_f32 v[198:199], v[198:199], v[246:247], v[198:199]
    v_pk_fma_f32 v[200:201], v[200:201], v[248:249], v[200:201]
    v_pk_fma_f32 v[202:203], v[202:203], v[250:251], v[202:203]
    v_pk_fma_f32 v[204:205], v[204:205], v[252:253], v[204:205]
    v_pk_fma_f32 v[206:207], v[206:207], v[254:255], v[206:207]
    s_cbranch_scc1 K2_X1
K2_L2:
    v_mfma_f32_32x32x8_bf16 v[224:239], a[130:131], v[8:9], v[32:47]
    v_exp_f32 v240, v208
    buffer_load_dwordx4 a[220:223], v3, s[4:7], 0 offen offset:0
    v_exp_f32 v241, v209
    v_exp_f32 v242, v210
    v_mfma_f32_32x32x16_bf16 v[224:239], a[16:19], a[236:239], v[224:239]
    v_exp_f32 v243, v211
    v_exp_f32 v244, v212
    v_exp_f32 v245, v213
    v_mfma_f32_32x32x16_bf16 v[224:239], a[20:23], a[240:243], v[224:239]
    v_exp_f32 v246, v214
    v_exp_f32 v247, v215
    v_exp_f32 v248, v216
    v_mfma_f32_32x32x16_bf16 v[224:239], a[24:27], a[244:247], v[224:239]
    v_exp_f32 v249, v217
    v_exp_f32 v250, v218
    v_exp_f32 v251, v219
    v_mfma_f32_32x32x16_bf16 v[224:239], a[28:31], a[248:251], v[224:239]
    v_exp_f32 v252, v220
    v_exp_f32 v253, v221
    v_exp_f32 v254, v222
    v_exp_f32 v255, v223
    v_cmpx_gt_i32 vcc, s23, v12
    v_pk_fma_f32 v[80:81], v[80:81], v[240:241], v[80:81]
    v_pk_fma_f32 v[82:83], v[82:83], v[242:243], v[82:83]
    v_pk_fma_f32 v[84:85], v[84:85], v[244:245], v[84:85]
    v_pk_fma_f32 v[86:87], v[86:87], v[246:247], v[86:87]
    v_pk_fma_f32 v[88:89], v[88:89], v[248:249], v[88:89]
    v_pk_fma_f32 v[90:91], v[90:91], v[250:251], v[90:91]
    v_pk_fma_f32 v[92:93], v[92:93], v[252:253], v[92:93]
    v_pk_fma_f32 v[94:95], v[94:95], v[254:255], v[94:95]
    v_pk_fma_f32 v[80:81], v[208:209], v[144:145], v[80:81]
    v_pk_fma_f32 v[82:83], v[210:211], v[146:147], v[82:83]
    v_pk_fma_f32 v[84:85], v[212:213], v[148:149], v[84:85]
    v_pk_fma_f32 v[86:87], v[214:215], v[150:151], v[86:87]
    v_pk_fma_f32 v[88:89], v[216:217], v[152:153], v[88:89]
    v_pk_fma_f32 v[90:91], v[218:219], v[154:155], v[90:91]
    v_pk_fma_f32 v[92:93], v[220:221], v[156:157], v[92:93]
    v_pk_fma_f32 v[94:95], v[222:223], v[158:159], v[94:95]
    v_pk_fma_f32 v[144:145], v[144:145], v[240:241], v[144:145]
    v_pk_fma_f32 v[146:147], v[146:147], v[242:243], v[146:147]
    v_pk_fma_f32 v[148:149], v[148:149], v[244:245], v[148:149]
    v_pk_fma_f32 v[150:151], v[150:151], v[246:247], v[150:151]
    v_pk_fma_f32 v[152:153], v[152:153], v[248:249], v[152:153]
    v_pk_fma_f32 v[154:155], v[154:155], v[250:251], v[154:155]
    v_pk_fma_f32 v[156:157], v[156:157], v[252:253], v[156:157]
    v_pk_fma_f32 v[158:159], v[158:159], v[254:255], v[158:159]
    v_mfma_f32_32x32x8_bf16 v[208:223], a[132:133], v[8:9], v[48:63]
    v_exp_f32 v240, v224
    buffer_load_dwordx4 a[224:227], v3, s[4:7], 0 offen offset:16
    v_exp_f32 v241, v225
    v_exp_f32 v242, v226
    v_mfma_f32_32x32x16_bf16 v[208:223], a[32:35], a[236:239], v[208:223]
    v_exp_f32 v243, v227
    v_exp_f32 v244, v228
    v_exp_f32 v245, v229
    v_mfma_f32_32x32x16_bf16 v[208:223], a[36:39], a[240:243], v[208:223]
    v_exp_f32 v246, v230
    v_exp_f32 v247, v231
    v_exp_f32 v248, v232
    v_mfma_f32_32x32x16_bf16 v[208:223], a[40:43], a[244:247], v[208:223]
    v_exp_f32 v249, v233
    v_exp_f32 v250, v234
    v_exp_f32 v251, v235
    v_mfma_f32_32x32x16_bf16 v[208:223], a[44:47], a[248:251], v[208:223]
    v_exp_f32 v252, v236
    v_exp_f32 v253, v237
    v_exp_f32 v254, v238
    v_exp_f32_e64 v255, v239
    s_sub_u32 s23, s23, 1
    v_pk_fma_f32 v[96:97], v[96:97], v[240:241], v[96:97]
    v_pk_fma_f32 v[98:99], v[98:99], v[242:243], v[98:99]
    v_pk_fma_f32 v[100:101], v[100:101], v[244:245], v[100:101]
    v_pk_fma_f32 v[102:103], v[102:103], v[246:247], v[102:103]
    v_pk_fma_f32 v[104:105], v[104:105], v[248:249], v[104:105]
    v_pk_fma_f32 v[106:107], v[106:107], v[250:251], v[106:107]
    v_pk_fma_f32 v[108:109], v[108:109], v[252:253], v[108:109]
    v_pk_fma_f32 v[110:111], v[110:111], v[254:255], v[110:111]
    v_pk_fma_f32 v[96:97], v[224:225], v[160:161], v[96:97]
    v_pk_fma_f32 v[98:99], v[226:227], v[162:163], v[98:99]
    v_pk_fma_f32 v[100:101], v[228:229], v[164:165], v[100:101]
    v_pk_fma_f32 v[102:103], v[230:231], v[166:167], v[102:103]
    v_pk_fma_f32 v[104:105], v[232:233], v[168:169], v[104:105]
    v_pk_fma_f32 v[106:107], v[234:235], v[170:171], v[106:107]
    v_pk_fma_f32 v[108:109], v[236:237], v[172:173], v[108:109]
    v_pk_fma_f32 v[110:111], v[238:239], v[174:175], v[110:111]
    v_pk_fma_f32 v[160:161], v[160:161], v[240:241], v[160:161]
    v_pk_fma_f32 v[162:163], v[162:163], v[242:243], v[162:163]
    v_pk_fma_f32 v[164:165], v[164:165], v[244:245], v[164:165]
    v_pk_fma_f32 v[166:167], v[166:167], v[246:247], v[166:167]
    v_pk_fma_f32 v[168:169], v[168:169], v[248:249], v[168:169]
    v_pk_fma_f32 v[170:171], v[170:171], v[250:251], v[170:171]
    v_pk_fma_f32 v[172:173], v[172:173], v[252:253], v[172:173]
    v_pk_fma_f32 v[174:175], v[174:175], v[254:255], v[174:175]
    v_mfma_f32_32x32x8_bf16 v[224:239], a[134:135], v[8:9], v[64:79]
    v_exp_f32 v240, v208
    buffer_load_dwordx4 a[228:231], v3, s[4:7], 0 offen offset:32
    v_exp_f32 v241, v209
    v_exp_f32 v242, v210
    v_mfma_f32_32x32x16_bf16 v[224:239], a[48:51], a[236:239], v[224:239]
    v_exp_f32 v243, v211
    v_exp_f32 v244, v212
    v_exp_f32 v245, v213
    v_mfma_f32_32x32x16_bf16 v[224:239], a[52:55], a[240:243], v[224:239]
    v_exp_f32 v246, v214
    v_exp_f32 v247, v215
    v_exp_f32 v248, v216
    v_mfma_f32_32x32x16_bf16 v[224:239], a[56:59], a[244:247], v[224:239]
    v_exp_f32 v249, v217
    v_exp_f32 v250, v218
    v_exp_f32 v251, v219
    v_mfma_f32_32x32x16_bf16 v[224:239], a[60:63], a[248:251], v[224:239]
    v_exp_f32 v252, v220
    v_exp_f32 v253, v221
    v_exp_f32 v254, v222
    v_exp_f32 v255, v223
    ds_read_b96 v[8:10], v7 offset:60
    v_pk_fma_f32 v[112:113], v[112:113], v[240:241], v[112:113]
    v_pk_fma_f32 v[114:115], v[114:115], v[242:243], v[114:115]
    v_pk_fma_f32 v[116:117], v[116:117], v[244:245], v[116:117]
    v_pk_fma_f32 v[118:119], v[118:119], v[246:247], v[118:119]
    v_pk_fma_f32 v[120:121], v[120:121], v[248:249], v[120:121]
    v_pk_fma_f32 v[122:123], v[122:123], v[250:251], v[122:123]
    v_pk_fma_f32 v[124:125], v[124:125], v[252:253], v[124:125]
    v_pk_fma_f32 v[126:127], v[126:127], v[254:255], v[126:127]
    v_pk_fma_f32 v[112:113], v[208:209], v[176:177], v[112:113]
    v_pk_fma_f32 v[114:115], v[210:211], v[178:179], v[114:115]
    v_pk_fma_f32 v[116:117], v[212:213], v[180:181], v[116:117]
    v_pk_fma_f32 v[118:119], v[214:215], v[182:183], v[118:119]
    v_pk_fma_f32 v[120:121], v[216:217], v[184:185], v[120:121]
    v_pk_fma_f32 v[122:123], v[218:219], v[186:187], v[122:123]
    v_pk_fma_f32 v[124:125], v[220:221], v[188:189], v[124:125]
    v_pk_fma_f32 v[126:127], v[222:223], v[190:191], v[126:127]
    v_pk_fma_f32 v[176:177], v[176:177], v[240:241], v[176:177]
    v_pk_fma_f32 v[178:179], v[178:179], v[242:243], v[178:179]
    v_pk_fma_f32 v[180:181], v[180:181], v[244:245], v[180:181]
    v_pk_fma_f32 v[182:183], v[182:183], v[246:247], v[182:183]
    v_pk_fma_f32 v[184:185], v[184:185], v[248:249], v[184:185]
    v_pk_fma_f32 v[186:187], v[186:187], v[250:251], v[186:187]
    v_pk_fma_f32 v[188:189], v[188:189], v[252:253], v[188:189]
    v_pk_fma_f32 v[190:191], v[190:191], v[254:255], v[190:191]
    v_mfma_f32_32x32x8_bf16 v[208:223], a[128:129], v[0:1], v[16:31]
    v_exp_f32 v240, v224
    s_waitcnt vmcnt(3)
    buffer_load_dwordx4 a[232:235], v3, s[4:7], 0 offen offset:48
    v_exp_f32 v241, v225
    v_exp_f32 v242, v226
    v_mfma_f32_32x32x16_bf16 v[208:223], a[0:3], a[204:207], v[208:223]
    v_exp_f32 v243, v227
    v_exp_f32 v244, v228
    v_exp_f32 v245, v229
    v_mfma_f32_32x32x16_bf16 v[208:223], a[4:7], a[208:211], v[208:223]
    v_exp_f32 v246, v230
    v_exp_f32 v247, v231
    v_exp_f32 v248, v232
    v_mfma_f32_32x32x16_bf16 v[208:223], a[8:11], a[212:215], v[208:223]
    v_exp_f32 v249, v233
    v_exp_f32 v250, v234
    v_exp_f32 v251, v235
    v_mfma_f32_32x32x16_bf16 v[208:223], a[12:15], a[216:219], v[208:223]
    v_exp_f32 v252, v236
    v_exp_f32 v253, v237
    v_exp_f32 v254, v238
    v_exp_f32 v255, v239
    s_waitcnt lgkmcnt(0)
    v_mad_u32_u16 v3, v10, s22, v11 op_sel:[1,0,0,0]
    v_add_u32_e64 v7, 36, v7
    v_pk_fma_f32 v[128:129], v[128:129], v[240:241], v[128:129]
    v_pk_fma_f32 v[130:131], v[130:131], v[242:243], v[130:131]
    v_pk_fma_f32 v[132:133], v[132:133], v[244:245], v[132:133]
    v_pk_fma_f32 v[134:135], v[134:135], v[246:247], v[134:135]
    v_pk_fma_f32 v[136:137], v[136:137], v[248:249], v[136:137]
    v_pk_fma_f32 v[138:139], v[138:139], v[250:251], v[138:139]
    v_pk_fma_f32 v[140:141], v[140:141], v[252:253], v[140:141]
    v_pk_fma_f32 v[142:143], v[142:143], v[254:255], v[142:143]
    v_pk_fma_f32 v[128:129], v[224:225], v[192:193], v[128:129]
    v_pk_fma_f32 v[130:131], v[226:227], v[194:195], v[130:131]
    v_pk_fma_f32 v[132:133], v[228:229], v[196:197], v[132:133]
    v_pk_fma_f32 v[134:135], v[230:231], v[198:199], v[134:135]
    v_pk_fma_f32 v[136:137], v[232:233], v[200:201], v[136:137]
    v_pk_fma_f32 v[138:139], v[234:235], v[202:203], v[138:139]
    v_pk_fma_f32 v[140:141], v[236:237], v[204:205], v[140:141]
    v_pk_fma_f32 v[142:143], v[238:239], v[206:207], v[142:143]
    v_pk_fma_f32 v[192:193], v[192:193], v[240:241], v[192:193]
    v_pk_fma_f32 v[194:195], v[194:195], v[242:243], v[194:195]
    v_pk_fma_f32 v[196:197], v[196:197], v[244:245], v[196:197]
    v_pk_fma_f32 v[198:199], v[198:199], v[246:247], v[198:199]
    v_pk_fma_f32 v[200:201], v[200:201], v[248:249], v[200:201]
    v_pk_fma_f32 v[202:203], v[202:203], v[250:251], v[202:203]
    v_pk_fma_f32 v[204:205], v[204:205], v[252:253], v[204:205]
    v_pk_fma_f32 v[206:207], v[206:207], v[254:255], v[206:207]
    s_cbranch_scc1 K2_X2
K2_L0:
    v_mfma_f32_32x32x8_bf16 v[224:239], a[130:131], v[0:1], v[32:47]
    v_exp_f32 v240, v208
    buffer_load_dwordx4 a[236:239], v3, s[4:7], 0 offen offset:0
    v_exp_f32 v241, v209
    v_exp_f32 v242, v210
    v_mfma_f32_32x32x16_bf16 v[224:239], a[16:19], a[204:207], v[224:239]
    v_exp_f32 v243, v211
    v_exp_f32 v244, v212
    v_exp_f32 v245, v213
    v_mfma_f32_32x32x16_bf16 v[224:239], a[20:23], a[208:211], v[224:239]
    v_exp_f32 v246, v214
    v_exp_f32 v247, v215
    v_exp_f32 v248, v216
    v_mfma_f32_32x32x16_bf16 v[224:239], a[24:27], a[212:215], v[224:239]
    v_exp_f32 v249, v217
    v_exp_f32 v250, v218
    v_exp_f32 v251, v219
    v_mfma_f32_32x32x16_bf16 v[224:239], a[28:31], a[216:219], v[224:239]
    v_exp_f32 v252, v220
    v_exp_f32 v253, v221
    v_exp_f32 v254, v222
    v_exp_f32 v255, v223
    v_cmpx_gt_i32 vcc, s23, v12
    v_pk_fma_f32 v[80:81], v[80:81], v[240:241], v[80:81]
    v_pk_fma_f32 v[82:83], v[82:83], v[242:243], v[82:83]
    v_pk_fma_f32 v[84:85], v[84:85], v[244:245], v[84:85]
    v_pk_fma_f32 v[86:87], v[86:87], v[246:247], v[86:87]
    v_pk_fma_f32 v[88:89], v[88:89], v[248:249], v[88:89]
    v_pk_fma_f32 v[90:91], v[90:91], v[250:251], v[90:91]
    v_pk_fma_f32 v[92:93], v[92:93], v[252:253], v[92:93]
    v_pk_fma_f32 v[94:95], v[94:95], v[254:255], v[94:95]
    v_pk_fma_f32 v[80:81], v[208:209], v[144:145], v[80:81]
    v_pk_fma_f32 v[82:83], v[210:211], v[146:147], v[82:83]
    v_pk_fma_f32 v[84:85], v[212:213], v[148:149], v[84:85]
    v_pk_fma_f32 v[86:87], v[214:215], v[150:151], v[86:87]
    v_pk_fma_f32 v[88:89], v[216:217], v[152:153], v[88:89]
    v_pk_fma_f32 v[90:91], v[218:219], v[154:155], v[90:91]
    v_pk_fma_f32 v[92:93], v[220:221], v[156:157], v[92:93]
    v_pk_fma_f32 v[94:95], v[222:223], v[158:159], v[94:95]
    v_pk_fma_f32 v[144:145], v[144:145], v[240:241], v[144:145]
    v_pk_fma_f32 v[146:147], v[146:147], v[242:243], v[146:147]
    v_pk_fma_f32 v[148:149], v[148:149], v[244:245], v[148:149]
    v_pk_fma_f32 v[150:151], v[150:151], v[246:247], v[150:151]
    v_pk_fma_f32 v[152:153], v[152:153], v[248:249], v[152:153]
    v_pk_fma_f32 v[154:155], v[154:155], v[250:251], v[154:155]
    v_pk_fma_f32 v[156:157], v[156:157], v[252:253], v[156:157]
    v_pk_fma_f32 v[158:159], v[158:159], v[254:255], v[158:159]
    v_mfma_f32_32x32x8_bf16 v[208:223], a[132:133], v[0:1], v[48:63]
    v_exp_f32 v240, v224
    buffer_load_dwordx4 a[240:243], v3, s[4:7], 0 offen offset:16
    v_exp_f32 v241, v225
    v_exp_f32 v242, v226
    v_mfma_f32_32x32x16_bf16 v[208:223], a[32:35], a[204:207], v[208:223]
    v_exp_f32 v243, v227
    v_exp_f32 v244, v228
    v_exp_f32 v245, v229
    v_mfma_f32_32x32x16_bf16 v[208:223], a[36:39], a[208:211], v[208:223]
    v_exp_f32 v246, v230
    v_exp_f32 v247, v231
    v_exp_f32 v248, v232
    v_mfma_f32_32x32x16_bf16 v[208:223], a[40:43], a[212:215], v[208:223]
    v_exp_f32 v249, v233
    v_exp_f32 v250, v234
    v_exp_f32 v251, v235
    v_mfma_f32_32x32x16_bf16 v[208:223], a[44:47], a[216:219], v[208:223]
    v_exp_f32 v252, v236
    v_exp_f32 v253, v237
    v_exp_f32 v254, v238
    v_exp_f32_e64 v255, v239
    s_sub_u32 s23, s23, 1
    v_pk_fma_f32 v[96:97], v[96:97], v[240:241], v[96:97]
    v_pk_fma_f32 v[98:99], v[98:99], v[242:243], v[98:99]
    v_pk_fma_f32 v[100:101], v[100:101], v[244:245], v[100:101]
    v_pk_fma_f32 v[102:103], v[102:103], v[246:247], v[102:103]
    v_pk_fma_f32 v[104:105], v[104:105], v[248:249], v[104:105]
    v_pk_fma_f32 v[106:107], v[106:107], v[250:251], v[106:107]
    v_pk_fma_f32 v[108:109], v[108:109], v[252:253], v[108:109]
    v_pk_fma_f32 v[110:111], v[110:111], v[254:255], v[110:111]
    v_pk_fma_f32 v[96:97], v[224:225], v[160:161], v[96:97]
    v_pk_fma_f32 v[98:99], v[226:227], v[162:163], v[98:99]
    v_pk_fma_f32 v[100:101], v[228:229], v[164:165], v[100:101]
    v_pk_fma_f32 v[102:103], v[230:231], v[166:167], v[102:103]
    v_pk_fma_f32 v[104:105], v[232:233], v[168:169], v[104:105]
    v_pk_fma_f32 v[106:107], v[234:235], v[170:171], v[106:107]
    v_pk_fma_f32 v[108:109], v[236:237], v[172:173], v[108:109]
    v_pk_fma_f32 v[110:111], v[238:239], v[174:175], v[110:111]
    v_pk_fma_f32 v[160:161], v[160:161], v[240:241], v[160:161]
    v_pk_fma_f32 v[162:163], v[162:163], v[242:243], v[162:163]
    v_pk_fma_f32 v[164:165], v[164:165], v[244:245], v[164:165]
    v_pk_fma_f32 v[166:167], v[166:167], v[246:247], v[166:167]
    v_pk_fma_f32 v[168:169], v[168:169], v[248:249], v[168:169]
    v_pk_fma_f32 v[170:171], v[170:171], v[250:251], v[170:171]
    v_pk_fma_f32 v[172:173], v[172:173], v[252:253], v[172:173]
    v_pk_fma_f32 v[174:175], v[174:175], v[254:255], v[174:175]
    v_mfma_f32_32x32x8_bf16 v[224:239], a[134:135], v[0:1], v[64:79]
    v_exp_f32 v240, v208
    buffer_load_dwordx4 a[244:247], v3, s[4:7], 0 offen offset:32
    v_exp_f32 v241, v209
    v_exp_f32 v242, v210
    v_mfma_f32_32x32x16_bf16 v[224:239], a[48:51], a[204:207], v[224:239]
    v_exp_f32 v243, v211
    v_exp_f32 v244, v212
    v_exp_f32 v245, v213
    v_mfma_f32_32x32x16_bf16 v[224:239], a[52:55], a[208:211], v[224:239]
    v_exp_f32 v246, v214
    v_exp_f32 v247, v215
    v_exp_f32 v248, v216
    v_mfma_f32_32x32x16_bf16 v[224:239], a[56:59], a[212:215], v[224:239]
    v_exp_f32 v249, v217
    v_exp_f32 v250, v218
    v_exp_f32 v251, v219
    v_mfma_f32_32x32x16_bf16 v[224:239], a[60:63], a[216:219], v[224:239]
    v_exp_f32 v252, v220
    v_exp_f32 v253, v221
    v_exp_f32 v254, v222
    v_exp_f32 v255, v223
    ds_read_b96 v[0:2], v7 offset:36
    v_pk_fma_f32 v[112:113], v[112:113], v[240:241], v[112:113]
    v_pk_fma_f32 v[114:115], v[114:115], v[242:243], v[114:115]
    v_pk_fma_f32 v[116:117], v[116:117], v[244:245], v[116:117]
    v_pk_fma_f32 v[118:119], v[118:119], v[246:247], v[118:119]
    v_pk_fma_f32 v[120:121], v[120:121], v[248:249], v[120:121]
    v_pk_fma_f32 v[122:123], v[122:123], v[250:251], v[122:123]
    v_pk_fma_f32 v[124:125], v[124:125], v[252:253], v[124:125]
    v_pk_fma_f32 v[126:127], v[126:127], v[254:255], v[126:127]
    v_pk_fma_f32 v[112:113], v[208:209], v[176:177], v[112:113]
    v_pk_fma_f32 v[114:115], v[210:211], v[178:179], v[114:115]
    v_pk_fma_f32 v[116:117], v[212:213], v[180:181], v[116:117]
    v_pk_fma_f32 v[118:119], v[214:215], v[182:183], v[118:119]
    v_pk_fma_f32 v[120:121], v[216:217], v[184:185], v[120:121]
    v_pk_fma_f32 v[122:123], v[218:219], v[186:187], v[122:123]
    v_pk_fma_f32 v[124:125], v[220:221], v[188:189], v[124:125]
    v_pk_fma_f32 v[126:127], v[222:223], v[190:191], v[126:127]
    v_pk_fma_f32 v[176:177], v[176:177], v[240:241], v[176:177]
    v_pk_fma_f32 v[178:179], v[178:179], v[242:243], v[178:179]
    v_pk_fma_f32 v[180:181], v[180:181], v[244:245], v[180:181]
    v_pk_fma_f32 v[182:183], v[182:183], v[246:247], v[182:183]
    v_pk_fma_f32 v[184:185], v[184:185], v[248:249], v[184:185]
    v_pk_fma_f32 v[186:187], v[186:187], v[250:251], v[186:187]
    v_pk_fma_f32 v[188:189], v[188:189], v[252:253], v[188:189]
    v_pk_fma_f32 v[190:191], v[190:191], v[254:255], v[190:191]
    v_mfma_f32_32x32x8_bf16 v[208:223], a[128:129], v[4:5], v[16:31]
    v_exp_f32 v240, v224
    s_waitcnt vmcnt(3)
    buffer_load_dwordx4 a[248:251], v3, s[4:7], 0 offen offset:48
    v_exp_f32 v241, v225
    v_exp_f32 v242, v226
    v_mfma_f32_32x32x16_bf16 v[208:223], a[0:3], a[220:223], v[208:223]
    v_exp_f32 v243, v227
    v_exp_f32 v244, v228
    v_exp_f32 v245, v229
    v_mfma_f32_32x32x16_bf16 v[208:223], a[4:7], a[224:227], v[208:223]
    v_exp_f32 v246, v230
    v_exp_f32 v247, v231
    v_exp_f32 v248, v232
    v_mfma_f32_32x32x16_bf16 v[208:223], a[8:11], a[228:231], v[208:223]
    v_exp_f32 v249, v233
    v_exp_f32 v250, v234
    v_exp_f32 v251, v235
    v_mfma_f32_32x32x16_bf16 v[208:223], a[12:15], a[232:235], v[208:223]
    v_exp_f32 v252, v236
    v_exp_f32 v253, v237
    v_exp_f32 v254, v238
    v_exp_f32 v255, v239
    s_waitcnt lgkmcnt(0)
    v_mad_u32_u16 v3, v2, s22, v11 op_sel:[1,0,0,0]
    v_pk_fma_f32 v[128:129], v[128:129], v[240:241], v[128:129]
    v_pk_fma_f32 v[130:131], v[130:131], v[242:243], v[130:131]
    v_pk_fma_f32 v[132:133], v[132:133], v[244:245], v[132:133]
    v_pk_fma_f32 v[134:135], v[134:135], v[246:247], v[134:135]
    v_pk_fma_f32 v[136:137], v[136:137], v[248:249], v[136:137]
    v_pk_fma_f32 v[138:139], v[138:139], v[250:251], v[138:139]
    v_pk_fma_f32 v[140:141], v[140:141], v[252:253], v[140:141]
    v_pk_fma_f32 v[142:143], v[142:143], v[254:255], v[142:143]
    v_pk_fma_f32 v[128:129], v[224:225], v[192:193], v[128:129]
    v_pk_fma_f32 v[130:131], v[226:227], v[194:195], v[130:131]
    v_pk_fma_f32 v[132:133], v[228:229], v[196:197], v[132:133]
    v_pk_fma_f32 v[134:135], v[230:231], v[198:199], v[134:135]
    v_pk_fma_f32 v[136:137], v[232:233], v[200:201], v[136:137]
    v_pk_fma_f32 v[138:139], v[234:235], v[202:203], v[138:139]
    v_pk_fma_f32 v[140:141], v[236:237], v[204:205], v[140:141]
    v_pk_fma_f32 v[142:143], v[238:239], v[206:207], v[142:143]
    v_pk_fma_f32 v[192:193], v[192:193], v[240:241], v[192:193]
    v_pk_fma_f32 v[194:195], v[194:195], v[242:243], v[194:195]
    v_pk_fma_f32 v[196:197], v[196:197], v[244:245], v[196:197]
    v_pk_fma_f32 v[198:199], v[198:199], v[246:247], v[198:199]
    v_pk_fma_f32 v[200:201], v[200:201], v[248:249], v[200:201]
    v_pk_fma_f32 v[202:203], v[202:203], v[250:251], v[202:203]
    v_pk_fma_f32 v[204:205], v[204:205], v[252:253], v[204:205]
    v_pk_fma_f32 v[206:207], v[206:207], v[254:255], v[206:207]
    s_cbranch_scc0 K2_L1
K2_X0:
    s_cmpk_eq_u32 s24, 129
    s_cbranch_scc1 K2_FINAL
    s_cmp_eq_u32 s24, 1
    s_cbranch_scc1 K2_TEND
    s_or_b32 s24, s24, 1
    s_mov_b32 s23, 1
    s_mov_b32 s6, 0
    v_add_u32 v12, 2, v12
    s_branch K2_L1
K2_X1:
    s_cmpk_eq_u32 s24, 129
    s_cbranch_scc1 K2_FINAL
    s_cmp_eq_u32 s24, 1
    s_cbranch_scc1 K2_TEND
    s_or_b32 s24, s24, 1
    s_mov_b32 s23, 1
    s_mov_b32 s6, 0
    v_add_u32 v12, 2, v12
    s_branch K2_L2
K2_X2:
    s_cmpk_eq_u32 s24, 129
    s_cbranch_scc1 K2_FINAL
    s_cmp_eq_u32 s24, 1
    s_cbranch_scc1 K2_TEND
    s_or_b32 s24, s24, 1
    s_mov_b32 s23, 1
    s_mov_b32 s6, 0
    v_add_u32 v12, 2, v12
    s_branch K2_L0
.p2align 12
K2_STUB3:
    s_branch K2_RET3
K2_TEND:
    s_mov_b64 exec, -1
    s_cmp_lg_u64 s[30:31], -1
    s_cbranch_scc1 K2_TFIX
.p2align 3
K2_TGO:
    v_accvgpr_read_b32 v7, a253
    v_accvgpr_read_b32 v14, a254
    ds_read_b32 v2, v7 offset:8
    v_accvgpr_read_b32 v242, a252
    s_mov_b32 s6, 6400000
    v_lshrrev_b32 v242, 16, v242
    v_cvt_f32_u32 v242, v242
    v_mov_b32 v241, 0
    v_mov_b32 v243, 0
    v_lshrrev_b32_e64 v240, 16, v242
    v_pk_mul_f32 v[252:253], v[144:145], v[152:153]
    v_pk_fma_f32 v[252:253], v[146:147], v[154:155], v[252:253]
    v_pk_fma_f32 v[252:253], v[148:149], v[156:157], v[252:253]
    v_pk_fma_f32 v[252:253], v[150:151], v[158:159], v[252:253]
    v_mfma_f32_32x32x8_bf16 v[208:223], v[240:241], a[138:139], 0
    v_mov_b32 v244, 0x3f80
    v_mov_b32 v245, 0
    v_mov_b32 v246, 1.0
    v_mov_b32 v247, 0
    v_mov_b32 v248, 0
    v_mov_b32 v249, 0x3f80
    v_mov_b32 v250, 0
    v_mfma_f32_32x32x8_bf16 v[224:239], v[242:243], a[138:139], 0
    v_mov_b32 v251, 1.0
    s_waitcnt lgkmcnt(0)
    v_mad_u32_u16 v3, v2, s22, v11 op_sel:[1,0,0,0]
    buffer_load_dwordx4 a[204:207], v3, s[4:7], 0 offen offset:0
    v_rcp_f32 v144, v144
    v_mfma_f32_32x32x8_bf16 v[16:31], a[136:137], v[244:245], 0
    v_rcp_f32 v145, v145
    v_rcp_f32 v146, v146
    v_rcp_f32 v147, v147
    v_rcp_f32 v148, v148
    v_mfma_f32_32x32x8_bf16 v[32:47], a[136:137], v[246:247], 0
    v_rcp_f32 v149, v149
    v_rcp_f32 v150, v150
    v_rcp_f32 v151, v151
    v_rcp_f32 v152, v152
    v_mfma_f32_32x32x8_bf16 v[48:63], a[136:137], v[248:249], 0
    s_waitcnt vmcnt(1)
    v_and_b32 v15, 0xffff, v14
    ds_read_b128 a[236:239], v15 offset:4224
    v_rcp_f32 v153, v153
    v_xor_b32 v12, 16, v15
    v_mfma_f32_32x32x8_bf16 v[64:79], a[136:137], v[250:251], 0
    ds_read_b128 a[240:243], v12 offset:4224
    v_rcp_f32 v154, v154
    v_xor_b32 v254, 32, v15
    ds_read_b128 a[244:247], v254 offset:4224
    v_rcp_f32 v155, v155
    v_xor_b32 v255, 48, v15
    ds_read_b128 a[248:251], v255 offset:4224
    v_rcp_f32 v156, v156
    buffer_load_dwordx4 a[208:211], v3, s[4:7], 0 offen offset:16
    v_rcp_f32 v157, v157
    v_rcp_f32 v158, v158
    v_rcp_f32_e64 v159, v159
    v_pk_mul_f32 v[80:81], v[80:81], v[144:145]
    v_pk_fma_f32 v[252:253], v[160:161], v[168:169], v[252:253]
    v_pk_mul_f32 v[82:83], v[82:83], v[146:147]
    v_pk_mul_f32 v[84:85], v[84:85], v[148:149]
    v_pk_fma_f32 v[252:253], v[162:163], v[170:171], v[252:253]
    v_pk_mul_f32 v[86:87], v[86:87], v[150:151]
    v_pk_mul_f32 v[88:89], v[88:89], v[152:153]
    v_pk_fma_f32 v[252:253], v[164:165], v[172:173], v[252:253]
    v_pk_mul_f32 v[90:91], v[90:91], v[154:155]
    v_pk_mul_f32 v[92:93], v[92:93], v[156:157]
    v_pk_fma_f32 v[252:253], v[166:167], v[174:175], v[252:253]
    v_pk_mul_f32 v[94:95], v[94:95], v[158:159]
    s_waitcnt lgkmcnt(0)
    v_mfma_f32_32x32x16_bf16 v[16:31], a[140:143], a[236:239], v[16:31]
    v_cvt_pk_bf16_f32 v144, v80, v81
    v_cvt_pk_bf16_f32 v145, v82, v83
    v_cvt_pk_bf16_f32 v146, v84, v85
    v_cvt_pk_bf16_f32 v147, v86, v87
    v_cvt_pk_bf16_f32 v148, v88, v89
    v_cvt_pk_bf16_f32 v149, v90, v91
    v_mfma_f32_32x32x16_bf16 v[16:31], a[144:147], a[240:243], v[16:31]
    v_cvt_pk_bf16_f32 v150, v92, v93
    v_cvt_pk_bf16_f32 v151, v94, v95
    v_rcp_f32 v160, v160
    ds_read2_b32 v[0:1], v7 offset0:0 offset1:1
    v_mfma_f32_32x32x16_bf16 v[16:31], a[148:151], a[244:247], v[16:31]
    v_rcp_f32 v161, v161
    ds_read_b96 v[4:6], v7 offset:12
    v_rcp_f32 v162, v162
    v_mfma_f32_32x32x16_bf16 v[16:31], a[152:155], a[248:251], v[16:31]
    buffer_load_dwordx4 a[212:215], v3, s[4:7], 0 offen offset:32
    v_rcp_f32 v163, v163
    ds_read_b96 v[8:10], v7 offset:24
    v_mfma_f32_32x32x16_bf16 v[208:223], v[144:147], a[64:67], v[208:223]
    v_rcp_f32 v164, v164
    v_accvgpr_write_b32 a252, v14
    v_rcp_f32 v165, v165
    v_lshrrev_b32 v240, 4, v11
    v_mfma_f32_32x32x16_bf16 v[224:239], v[144:147], a[68:71], v[224:239]
    v_rcp_f32 v166, v166
    v_sub_u32 v240, s38, v240
    v_rcp_f32 v167, v167
    buffer_load_dwordx4 a[216:219], v3, s[4:7], 0 offen offset:48
    v_mfma_f32_32x32x16_bf16 v[208:223], v[148:151], a[72:75], v[208:223]
    v_rcp_f32 v168, v168
    v_rcp_f32 v169, v169
    v_rcp_f32 v170, v170
    v_mfma_f32_32x32x16_bf16 v[224:239], v[148:151], a[76:79], v[224:239]
    v_rcp_f32 v171, v171
    v_rcp_f32 v172, v172
    v_rcp_f32 v173, v173
    v_mfma_f32_32x32x16_bf16 v[48:63], a[172:175], a[236:239], v[48:63]
    v_rcp_f32 v174, v174
    v_rcp_f32_e64 v175, v175
    v_pk_mul_f32 v[96:97], v[96:97], v[160:161]
    v_pk_fma_f32 v[252:253], v[176:177], v[184:185], v[252:253]
    v_pk_mul_f32 v[98:99], v[98:99], v[162:163]
    v_pk_mul_f32 v[100:101], v[100:101], v[164:165]
    v_pk_fma_f32 v[252:253], v[178:179], v[186:187], v[252:253]
    v_pk_mul_f32 v[102:103], v[102:103], v[166:167]
    v_pk_mul_f32 v[104:105], v[104:105], v[168:169]
    v_pk_fma_f32 v[252:253], v[180:181], v[188:189], v[252:253]
    v_pk_mul_f32 v[106:107], v[106:107], v[170:171]
    v_pk_mul_f32 v[108:109], v[108:109], v[172:173]
    v_pk_fma_f32 v[252:253], v[182:183], v[190:191], v[252:253]
    v_pk_mul_f32 v[110:111], v[110:111], v[174:175]
    v_mfma_f32_32x32x16_bf16 v[32:47], a[156:159], a[236:239], v[32:47]
    v_cvt_pk_bf16_f32 v160, v96, v97
    v_cvt_pk_bf16_f32 v161, v98, v99
    v_cvt_pk_bf16_f32 v162, v100, v101
    v_cvt_pk_bf16_f32 v163, v102, v103
    v_cvt_pk_bf16_f32 v164, v104, v105
    v_cvt_pk_bf16_f32 v165, v106, v107
    v_mfma_f32_32x32x16_bf16 v[32:47], a[160:163], a[240:243], v[32:47]
    v_cvt_pk_bf16_f32 v166, v108, v109
    v_cvt_pk_bf16_f32 v167, v110, v111
    v_rcp_f32 v176, v176
    s_waitcnt lgkmcnt(0)
    v_rcp_f32 v177, v177
    v_mfma_f32_32x32x16_bf16 v[32:47], a[164:167], a[244:247], v[32:47]
    v_mad_u32_u16 v3, v6, s22, v11 op_sel:[1,0,0,0]
    v_rcp_f32 v178, v178
    v_lshrrev_b32 v15, 4, v13
    v_rcp_f32 v179, v179
    v_mfma_f32_32x32x16_bf16 v[32:47], a[168:171], a[248:251], v[32:47]
    v_lshl_add_u32 v15, v15, 5, s25
    v_rcp_f32 v180, v180
    ds_read_b128 v[168:171], v15 offset:3200
    v_rcp_f32 v181, v181
    v_mfma_f32_32x32x16_bf16 v[208:223], v[160:163], a[80:83], v[208:223]
    ds_read_b128 v[172:175], v15 offset:3216
    v_rcp_f32 v182, v182
    v_and_b32 v15, 15, v13
    v_rcp_f32 v183, v183
    v_mfma_f32_32x32x16_bf16 v[224:239], v[160:163], a[84:87], v[224:239]
    buffer_load_dwordx4 a[220:223], v3, s[4:7], 0 offen offset:0
    v_rcp_f32 v184, v184
    s_add_u32 s25, s25, 128
    v_mfma_f32_32x32x16_bf16 v[208:223], v[164:167], a[88:91], v[208:223]
    v_rcp_f32 v185, v185
    v_lshrrev_b32 v12, 16, v14
    v_rcp_f32 v186, v186
    s_movk_i32 s24, 128
    v_mfma_f32_32x32x16_bf16 v[224:239], v[164:167], a[92:95], v[224:239]
    v_rcp_f32 v187, v187
    v_readlane_b32 s26, v12, 0
    v_rcp_f32 v188, v188
    v_readlane_b32 s27, v12, s29
    v_mfma_f32_32x32x16_bf16 v[48:63], a[176:179], a[240:243], v[48:63]
    v_rcp_f32 v189, v189
    v_cmp_lt_u32 s[30:31], 0, v12
    v_rcp_f32 v190, v190
    v_rcp_f32_e64 v191, v191
    v_pk_mul_f32 v[112:113], v[112:113], v[176:177]
    v_pk_fma_f32 v[252:253], v[192:193], v[200:201], v[252:253]
    v_pk_mul_f32 v[114:115], v[114:115], v[178:179]
    v_pk_mul_f32 v[116:117], v[116:117], v[180:181]
    v_pk_fma_f32 v[252:253], v[194:195], v[202:203], v[252:253]
    v_pk_mul_f32 v[118:119], v[118:119], v[182:183]
    v_pk_mul_f32 v[120:121], v[120:121], v[184:185]
    v_pk_fma_f32 v[252:253], v[196:197], v[204:205], v[252:253]
    v_pk_mul_f32 v[122:123], v[122:123], v[186:187]
    v_pk_mul_f32 v[124:125], v[124:125], v[188:189]
    v_pk_fma_f32 v[252:253], v[198:199], v[206:207], v[252:253]
    v_pk_mul_f32 v[126:127], v[126:127], v[190:191]
    v_mfma_f32_32x32x8_bf16 v[80:95], a[128:129], v[0:1], v[16:31]
    v_cvt_pk_bf16_f32 v176, v112, v113
    v_cvt_pk_bf16_f32 v177, v114, v115
    v_cvt_pk_bf16_f32 v178, v116, v117
    v_cvt_pk_bf16_f32 v179, v118, v119
    v_cvt_pk_bf16_f32 v180, v120, v121
    v_cvt_pk_bf16_f32 v181, v122, v123
    v_cvt_pk_bf16_f32 v182, v124, v125
    v_mfma_f32_32x32x16_bf16 v[208:223], v[176:179], a[96:99], v[208:223]
    v_cvt_pk_bf16_f32 v183, v126, v127
    v_rcp_f32 v192, v192
    buffer_load_dwordx4 a[224:227], v3, s[4:7], 0 offen offset:16
    v_mfma_f32_32x32x16_bf16 v[224:239], v[176:179], a[100:103], v[224:239]
    v_rcp_f32 v193, v193
    s_waitcnt lgkmcnt(0)
    v_rcp_f32 v194, v194
    v_add_f32 v252, v252, v253
    v_mfma_f32_32x32x16_bf16 v[208:223], v[180:183], a[104:107], v[208:223]
    v_rcp_f32 v195, v195
    v_lshl_add_u32 v168, v15, 3, v168
    v_rcp_f32 v196, v196
    s_waitcnt vmcnt(2)
    v_mfma_f32_32x32x16_bf16 v[224:239], v[180:183], a[108:111], v[224:239]
    v_lshl_add_u32 v172, v15, 3, v172
    v_rcp_f32 v197, v197
    v_lshl_add_u32 v169, v15, 3, v169
    v_rcp_f32 v198, v198
    v_mfma_f32_32x32x16_bf16 v[80:95], a[0:3], a[204:207], v[80:95]
    v_lshl_add_u32 v173, v15, 3, v173
    v_rcp_f32 v199, v199
    v_lshl_add_u32 v170, v15, 3, v170
    v_rcp_f32 v200, v200
    v_mfma_f32_32x32x16_bf16 v[80:95], a[4:7], a[208:211], v[80:95]
    v_lshl_add_u32 v174, v15, 3, v174
    v_rcp_f32 v201, v201
    v_lshl_add_u32 v171, v15, 3, v171
    v_rcp_f32 v202, v202
    v_mfma_f32_32x32x16_bf16 v[80:95], a[8:11], a[212:215], v[80:95]
    v_lshl_add_u32 v175, v15, 3, v175
    v_rcp_f32 v203, v203
    buffer_load_dwordx4 a[228:231], v3, s[4:7], 0 offen offset:32
    v_mfma_f32_32x32x16_bf16 v[80:95], a[12:15], a[216:219], v[80:95]
    v_rcp_f32 v204, v204
    v_rcp_f32 v205, v205
    v_rcp_f32 v206, v206
    v_rcp_f32_e64 v207, v207
    v_pk_mul_f32 v[128:129], v[128:129], v[192:193]
    v_pk_mul_f32 v[130:131], v[130:131], v[194:195]
    v_pk_mul_f32 v[132:133], v[132:133], v[196:197]
    v_pk_mul_f32 v[134:135], v[134:135], v[198:199]
    v_pk_mul_f32 v[136:137], v[136:137], v[200:201]
    v_pk_mul_f32 v[138:139], v[138:139], v[202:203]
    v_pk_mul_f32 v[140:141], v[140:141], v[204:205]
    v_pk_mul_f32 v[142:143], v[142:143], v[206:207]
    v_mfma_f32_32x32x16_bf16 v[48:63], a[180:183], a[244:247], v[48:63]
    v_cvt_pk_bf16_f32 v192, v128, v129
    v_cvt_pk_bf16_f32 v193, v130, v131
    v_cvt_pk_bf16_f32 v194, v132, v133
    v_cvt_pk_bf16_f32 v195, v134, v135
    v_cvt_pk_bf16_f32 v196, v136, v137
    v_cvt_pk_bf16_f32 v197, v138, v139
    v_mfma_f32_32x32x16_bf16 v[208:223], v[192:195], a[112:115], v[208:223]
    v_cvt_pk_bf16_f32 v198, v140, v141
    v_cvt_pk_bf16_f32 v199, v142, v143
    v_exp_f32 v144, v80
    v_exp_f32 v145, v81
    v_mfma_f32_32x32x16_bf16 v[224:239], v[192:195], a[116:119], v[224:239]
    v_exp_f32 v146, v82
    v_exp_f32 v147, v83
    v_exp_f32 v148, v84
    v_mfma_f32_32x32x16_bf16 v[208:223], v[196:199], a[120:123], v[208:223]
    v_exp_f32 v149, v85
    v_exp_f32 v150, v86
    v_exp_f32 v151, v87
    v_mfma_f32_32x32x16_bf16 v[224:239], v[196:199], a[124:127], v[224:239]
    v_exp_f32 v152, v88
    v_exp_f32 v153, v89
    v_exp_f32 v154, v90
    v_mfma_f32_32x32x16_bf16 v[48:63], a[184:187], a[248:251], v[48:63]
    v_exp_f32 v155, v91
    v_exp_f32 v156, v92
    v_exp_f32 v157, v93
    v_exp_f32 v158, v94
    v_exp_f32_e64 v159, v95
    buffer_load_dwordx4 a[232:235], v3, s[4:7], 0 offen offset:48
    v_mad_u32_u16 v3, v10, s22, v11 op_sel:[1,0,0,0]
    s_max_u32 s26, s26, s27
    s_max_u32 s26, s26, 4
    s_sub_u32 s23, s26, 4
    s_sub_u32 s26, s26, 3
    v_sub_u32 v12, s26, v12
    v_pk_add_f32 v[144:145], v[144:145], 1.0 op_sel_hi:[1,0]
    v_pk_add_f32 v[146:147], v[146:147], 1.0 op_sel_hi:[1,0]
    v_pk_add_f32 v[148:149], v[148:149], 1.0 op_sel_hi:[1,0]
    v_pk_add_f32 v[150:151], v[150:151], 1.0 op_sel_hi:[1,0]
    v_pk_add_f32 v[152:153], v[152:153], 1.0 op_sel_hi:[1,0]
    v_pk_add_f32 v[154:155], v[154:155], 1.0 op_sel_hi:[1,0]
    v_pk_add_f32 v[156:157], v[156:157], 1.0 op_sel_hi:[1,0]
    v_pk_add_f32 v[158:159], v[158:159], 1.0 op_sel_hi:[1,0]
    v_cmpx_lt_i32_e64 vcc, 0, v240
    v_pk_add_f32 v[208:209], v[208:209], v[210:211]
    v_pk_add_f32 v[224:225], v[224:225], v[226:227]
    s_mov_b64 exec, -1
    v_cvt_pk_bf16_f32 v176, v208, v224
    v_mfma_f32_32x32x8_bf16 v[96:111], a[130:131], v[0:1], v[32:47]
    v_cvt_pk_bf16_f32 v177, v209, v225
    v_cvt_pk_bf16_f32 v178, v210, v226
    v_cvt_pk_bf16_f32 v179, v211, v227
    v_permlane16_swap_b32 v176, v177
    v_cvt_pk_bf16_f32 v180, v212, v228
    v_cvt_pk_bf16_f32 v181, v213, v229
    v_permlane16_swap_b32 v178, v179
    v_mfma_f32_32x32x16_bf16 v[96:111], a[16:19], a[204:207], v[96:111]
    buffer_store_dwordx2 v[176:177], v168, s[8:11], 0 offen sc1
    v_cvt_pk_bf16_f32 v182, v214, v230
    v_cvt_pk_bf16_f32 v183, v215, v231
    v_permlane16_swap_b32 v180, v181
    v_mfma_f32_32x32x16_bf16 v[96:111], a[20:23], a[208:211], v[96:111]
    buffer_store_dwordx2 v[178:179], v172, s[8:11], 0 offen sc1
    v_cvt_pk_bf16_f32 v184, v216, v232
    v_cvt_pk_bf16_f32 v185, v217, v233
    v_permlane16_swap_b32 v182, v183
    v_mfma_f32_32x32x16_bf16 v[96:111], a[24:27], a[212:215], v[96:111]
    buffer_store_dwordx2 v[180:181], v169, s[8:11], 0 offen sc1
    v_cvt_pk_bf16_f32 v186, v218, v234
    v_cvt_pk_bf16_f32 v187, v219, v235
    v_permlane16_swap_b32 v184, v185
    v_mfma_f32_32x32x16_bf16 v[96:111], a[28:31], a[216:219], v[96:111]
    buffer_store_dwordx2 v[182:183], v173, s[8:11], 0 offen sc1
    v_cvt_pk_bf16_f32 v188, v220, v236
    v_cvt_pk_bf16_f32 v189, v221, v237
    v_permlane16_swap_b32 v186, v187
    v_mfma_f32_32x32x16_bf16 v[64:79], a[188:191], a[236:239], v[64:79]
    buffer_store_dwordx2 v[184:185], v170, s[8:11], 0 offen sc1
    v_cvt_pk_bf16_f32 v190, v222, v238
    v_cvt_pk_bf16_f32 v191, v223, v239
    v_permlane16_swap_b32 v188, v189
    v_mfma_f32_32x32x16_bf16 v[64:79], a[192:195], a[240:243], v[64:79]
    buffer_store_dwordx2 v[186:187], v174, s[8:11], 0 offen sc1
    v_maximum3_f32 v252, v252, |v208|, |v209|
    v_maximum3_f32 v252, v252, |v210|, |v211|
    v_permlane16_swap_b32 v190, v191
    v_mfma_f32_32x32x16_bf16 v[64:79], a[196:199], a[244:247], v[64:79]
    buffer_store_dwordx2 v[188:189], v171, s[8:11], 0 offen sc1
    v_maximum3_f32 v252, v252, |v212|, |v213|
    v_maximum3_f32 v252, v252, |v214|, |v215|
    buffer_store_dwordx2 v[190:191], v175, s[8:11], 0 offen sc1
    v_mfma_f32_32x32x16_bf16 v[64:79], a[200:203], a[248:251], v[64:79]
    v_maximum3_f32 v252, v252, |v216|, |v217|
    v_maximum3_f32 v252, v252, |v218|, |v219|
    v_maximum3_f32 v252, v252, |v220|, |v221|
    v_maximum3_f32 v252, v252, |v222|, |v223|
    v_cmp_ngt_f32 vcc, 0x7e800000, v252
    s_or_b64 s[34:35], s[34:35], vcc
.p2align 3
    s_mov_b64 exec, s[30:31]
    v_mfma_f32_32x32x8_bf16 v[112:127], a[132:133], v[0:1], v[48:63]
    v_exp_f32 v160, v96
    buffer_load_dwordx4 a[236:239], v3, s[4:7], 0 offen offset:0
    v_exp_f32 v161, v97
    v_exp_f32 v162, v98
    v_mfma_f32_32x32x16_bf16 v[112:127], a[32:35], a[204:207], v[112:127]
    v_exp_f32 v163, v99
    v_exp_f32 v164, v100
    v_exp_f32 v165, v101
    v_mfma_f32_32x32x16_bf16 v[112:127], a[36:39], a[208:211], v[112:127]
    v_exp_f32 v166, v102
    v_exp_f32 v167, v103
    v_exp_f32 v168, v104
    v_mfma_f32_32x32x16_bf16 v[112:127], a[40:43], a[212:215], v[112:127]
    v_exp_f32 v169, v105
    v_exp_f32 v170, v106
    v_exp_f32 v171, v107
    v_mfma_f32_32x32x16_bf16 v[112:127], a[44:47], a[216:219], v[112:127]
    v_exp_f32 v172, v108
    v_exp_f32 v173, v109
    v_exp_f32 v174, v110
    v_exp_f32_e64 v175, v111
    buffer_load_dwordx4 a[240:243], v3, s[4:7], 0 offen offset:16
    v_pk_add_f32 v[160:161], v[160:161], 1.0 op_sel_hi:[1,0]
    v_pk_add_f32 v[162:163], v[162:163], 1.0 op_sel_hi:[1,0]
    v_pk_add_f32 v[164:165], v[164:165], 1.0 op_sel_hi:[1,0]
    v_pk_add_f32 v[166:167], v[166:167], 1.0 op_sel_hi:[1,0]
    v_pk_add_f32 v[168:169], v[168:169], 1.0 op_sel_hi:[1,0]
    v_pk_add_f32 v[170:171], v[170:171], 1.0 op_sel_hi:[1,0]
    v_pk_add_f32 v[172:173], v[172:173], 1.0 op_sel_hi:[1,0]
    v_pk_add_f32 v[174:175], v[174:175], 1.0 op_sel_hi:[1,0]
    v_mfma_f32_32x32x8_bf16 v[128:143], a[134:135], v[0:1], v[64:79]
    v_exp_f32 v176, v112
    buffer_load_dwordx4 a[244:247], v3, s[4:7], 0 offen offset:32
    v_exp_f32 v177, v113
    v_exp_f32 v178, v114
    v_mfma_f32_32x32x16_bf16 v[128:143], a[48:51], a[204:207], v[128:143]
    v_exp_f32 v179, v115
    v_exp_f32 v180, v116
    v_exp_f32 v181, v117
    v_mfma_f32_32x32x16_bf16 v[128:143], a[52:55], a[208:211], v[128:143]
    v_exp_f32 v182, v118
    v_exp_f32 v183, v119
    v_exp_f32 v184, v120
    v_mfma_f32_32x32x16_bf16 v[128:143], a[56:59], a[212:215], v[128:143]
    v_exp_f32 v185, v121
    v_exp_f32 v186, v122
    v_exp_f32 v187, v123
    v_mfma_f32_32x32x16_bf16 v[128:143], a[60:63], a[216:219], v[128:143]
    v_exp_f32 v188, v124
    v_exp_f32 v189, v125
    v_exp_f32 v190, v126
    v_exp_f32 v191, v127
    ds_read_b96 v[0:2], v7 offset:36
    v_pk_add_f32 v[176:177], v[176:177], 1.0 op_sel_hi:[1,0]
    v_pk_add_f32 v[178:179], v[178:179], 1.0 op_sel_hi:[1,0]
    v_pk_add_f32 v[180:181], v[180:181], 1.0 op_sel_hi:[1,0]
    v_pk_add_f32 v[182:183], v[182:183], 1.0 op_sel_hi:[1,0]
    v_pk_add_f32 v[184:185], v[184:185], 1.0 op_sel_hi:[1,0]
    v_pk_add_f32 v[186:187], v[186:187], 1.0 op_sel_hi:[1,0]
    v_pk_add_f32 v[188:189], v[188:189], 1.0 op_sel_hi:[1,0]
    v_pk_add_f32 v[190:191], v[190:191], 1.0 op_sel_hi:[1,0]
    v_mfma_f32_32x32x8_bf16 v[208:223], a[128:129], v[4:5], v[16:31]
    v_exp_f32 v192, v128
    s_waitcnt vmcnt(11)
    buffer_load_dwordx4 a[248:251], v3, s[4:7], 0 offen offset:48
    v_exp_f32 v193, v129
    v_exp_f32 v194, v130
    v_mfma_f32_32x32x16_bf16 v[208:223], a[0:3], a[220:223], v[208:223]
    v_exp_f32 v195, v131
    v_exp_f32 v196, v132
    v_exp_f32 v197, v133
    v_mfma_f32_32x32x16_bf16 v[208:223], a[4:7], a[224:227], v[208:223]
    v_exp_f32 v198, v134
    v_exp_f32 v199, v135
    v_exp_f32 v200, v136
    v_mfma_f32_32x32x16_bf16 v[208:223], a[8:11], a[228:231], v[208:223]
    v_exp_f32 v201, v137
    v_exp_f32 v202, v138
    v_exp_f32 v203, v139
    v_mfma_f32_32x32x16_bf16 v[208:223], a[12:15], a[232:235], v[208:223]
    v_exp_f32 v204, v140
    v_exp_f32 v205, v141
    v_exp_f32 v206, v142
    v_exp_f32 v207, v143
    s_waitcnt lgkmcnt(0)
    v_mad_u32_u16 v3, v2, s22, v11 op_sel:[1,0,0,0]
    v_pk_add_f32 v[192:193], v[192:193], 1.0 op_sel_hi:[1,0]
    v_pk_add_f32 v[194:195], v[194:195], 1.0 op_sel_hi:[1,0]
    v_pk_add_f32 v[196:197], v[196:197], 1.0 op_sel_hi:[1,0]
    v_pk_add_f32 v[198:199], v[198:199], 1.0 op_sel_hi:[1,0]
    v_pk_add_f32 v[200:201], v[200:201], 1.0 op_sel_hi:[1,0]
    v_pk_add_f32 v[202:203], v[202:203], 1.0 op_sel_hi:[1,0]
    v_pk_add_f32 v[204:205], v[204:205], 1.0 op_sel_hi:[1,0]
    v_pk_add_f32 v[206:207], v[206:207], 1.0 op_sel_hi:[1,0]
    s_branch K2_L1
K2_FINAL:
    s_mov_b64 exec, -1
    s_cmp_lg_u64 s[30:31], -1
    s_cbranch_scc1 K2_FFIX
.p2align 3
K2_FGO:
    v_accvgpr_read_b32 v242, a252
    v_lshrrev_b32 v242, 16, v242
    v_cvt_f32_u32 v242, v242
    v_mov_b32 v241, 0
    v_mov_b32 v243, 0
    v_lshrrev_b32_e64 v240, 16, v242
    v_pk_mul_f32 v[252:253], v[144:145], v[152:153]
    v_pk_fma_f32 v[252:253], v[146:147], v[154:155], v[252:253]
    v_pk_fma_f32 v[252:253], v[148:149], v[156:157], v[252:253]
    v_pk_fma_f32 v[252:253], v[150:151], v[158:159], v[252:253]
    v_mfma_f32_32x32x8_bf16 v[208:223], v[240:241], a[138:139], 0
    v_rcp_f32 v144, v144
    v_rcp_f32 v145, v145
    v_rcp_f32 v146, v146
    v_rcp_f32 v147, v147
    v_mfma_f32_32x32x8_bf16 v[224:239], v[242:243], a[138:139], 0
    v_rcp_f32 v148, v148
    v_rcp_f32 v149, v149
    v_rcp_f32 v150, v150
    v_rcp_f32 v151, v151
    v_rcp_f32 v152, v152
    v_rcp_f32 v153, v153
    v_rcp_f32 v154, v154
    v_rcp_f32 v155, v155
    v_rcp_f32 v156, v156
    v_rcp_f32 v157, v157
    v_rcp_f32 v158, v158
    v_rcp_f32 v159, v159
    v_pk_mul_f32 v[80:81], v[80:81], v[144:145]
    v_pk_fma_f32 v[252:253], v[160:161], v[168:169], v[252:253]
    v_pk_mul_f32 v[82:83], v[82:83], v[146:147]
    v_pk_mul_f32 v[84:85], v[84:85], v[148:149]
    v_pk_fma_f32 v[252:253], v[162:163], v[170:171], v[252:253]
    v_pk_mul_f32 v[86:87], v[86:87], v[150:151]
    v_pk_mul_f32 v[88:89], v[88:89], v[152:153]
    v_pk_fma_f32 v[252:253], v[164:165], v[172:173], v[252:253]
    v_pk_mul_f32 v[90:91], v[90:91], v[154:155]
    v_pk_mul_f32 v[92:93], v[92:93], v[156:157]
    v_pk_fma_f32 v[252:253], v[166:167], v[174:175], v[252:253]
    v_pk_mul_f32 v[94:95], v[94:95], v[158:159]
    v_cvt_pk_bf16_f32 v144, v80, v81
    v_cvt_pk_bf16_f32 v145, v82, v83
    v_cvt_pk_bf16_f32 v146, v84, v85
    v_cvt_pk_bf16_f32 v147, v86, v87
    v_cvt_pk_bf16_f32 v148, v88, v89
    v_cvt_pk_bf16_f32 v149, v90, v91
    v_mfma_f32_32x32x16_bf16 v[208:223], v[144:147], a[64:67], v[208:223]
    v_cvt_pk_bf16_f32 v150, v92, v93
    v_cvt_pk_bf16_f32 v151, v94, v95
    v_rcp_f32 v160, v160
    v_rcp_f32 v161, v161
    v_mfma_f32_32x32x16_bf16 v[224:239], v[144:147], a[68:71], v[224:239]
    v_rcp_f32 v162, v162
    v_rcp_f32 v163, v163
    v_rcp_f32 v164, v164
    v_mfma_f32_32x32x16_bf16 v[208:223], v[148:151], a[72:75], v[208:223]
    v_rcp_f32 v165, v165
    v_rcp_f32 v166, v166
    v_rcp_f32 v167, v167
    v_mfma_f32_32x32x16_bf16 v[224:239], v[148:151], a[76:79], v[224:239]
    v_rcp_f32 v168, v168
    v_rcp_f32 v169, v169
    v_rcp_f32 v170, v170
    v_rcp_f32 v171, v171
    v_rcp_f32 v172, v172
    v_rcp_f32 v173, v173
    v_rcp_f32 v174, v174
    v_rcp_f32 v175, v175
    v_pk_mul_f32 v[96:97], v[96:97], v[160:161]
    v_pk_fma_f32 v[252:253], v[176:177], v[184:185], v[252:253]
    v_pk_mul_f32 v[98:99], v[98:99], v[162:163]
    v_pk_mul_f32 v[100:101], v[100:101], v[164:165]
    v_pk_fma_f32 v[252:253], v[178:179], v[186:187], v[252:253]
    v_pk_mul_f32 v[102:103], v[102:103], v[166:167]
    v_pk_mul_f32 v[104:105], v[104:105], v[168:169]
    v_pk_fma_f32 v[252:253], v[180:181], v[188:189], v[252:253]
    v_pk_mul_f32 v[106:107], v[106:107], v[170:171]
    v_pk_mul_f32 v[108:109], v[108:109], v[172:173]
    v_pk_fma_f32 v[252:253], v[182:183], v[190:191], v[252:253]
    v_pk_mul_f32 v[110:111], v[110:111], v[174:175]
    v_cvt_pk_bf16_f32 v160, v96, v97
    v_cvt_pk_bf16_f32 v161, v98, v99
    v_cvt_pk_bf16_f32 v162, v100, v101
    v_cvt_pk_bf16_f32 v163, v102, v103
    v_cvt_pk_bf16_f32 v164, v104, v105
    v_cvt_pk_bf16_f32 v165, v106, v107
    v_mfma_f32_32x32x16_bf16 v[208:223], v[160:163], a[80:83], v[208:223]
    v_cvt_pk_bf16_f32 v166, v108, v109
    v_cvt_pk_bf16_f32 v167, v110, v111
    v_rcp_f32 v176, v176
    v_rcp_f32 v177, v177
    v_mfma_f32_32x32x16_bf16 v[224:239], v[160:163], a[84:87], v[224:239]
    v_rcp_f32 v178, v178
    v_rcp_f32 v179, v179
    v_rcp_f32 v180, v180
    v_mfma_f32_32x32x16_bf16 v[208:223], v[164:167], a[88:91], v[208:223]
    v_rcp_f32 v181, v181
    v_rcp_f32 v182, v182
    v_rcp_f32 v183, v183
    v_mfma_f32_32x32x16_bf16 v[224:239], v[164:167], a[92:95], v[224:239]
    v_rcp_f32 v184, v184
    v_rcp_f32 v185, v185
    v_rcp_f32 v186, v186
    v_rcp_f32 v187, v187
    v_rcp_f32 v188, v188
    v_rcp_f32 v189, v189
    v_rcp_f32 v190, v190
    v_rcp_f32 v191, v191
    v_pk_mul_f32 v[112:113], v[112:113], v[176:177]
    v_pk_fma_f32 v[252:253], v[192:193], v[200:201], v[252:253]
    v_pk_mul_f32 v[114:115], v[114:115], v[178:179]
    v_pk_mul_f32 v[116:117], v[116:117], v[180:181]
    v_pk_fma_f32 v[252:253], v[194:195], v[202:203], v[252:253]
    v_pk_mul_f32 v[118:119], v[118:119], v[182:183]
    v_pk_mul_f32 v[120:121], v[120:121], v[184:185]
    v_pk_fma_f32 v[252:253], v[196:197], v[204:205], v[252:253]
    v_pk_mul_f32 v[122:123], v[122:123], v[186:187]
    v_pk_mul_f32 v[124:125], v[124:125], v[188:189]
    v_pk_fma_f32 v[252:253], v[198:199], v[206:207], v[252:253]
    v_pk_mul_f32 v[126:127], v[126:127], v[190:191]
    v_cvt_pk_bf16_f32 v176, v112, v113
    v_cvt_pk_bf16_f32 v177, v114, v115
    v_cvt_pk_bf16_f32 v178, v116, v117
    v_cvt_pk_bf16_f32 v179, v118, v119
    v_cvt_pk_bf16_f32 v180, v120, v121
    v_cvt_pk_bf16_f32 v181, v122, v123
    v_mfma_f32_32x32x16_bf16 v[208:223], v[176:179], a[96:99], v[208:223]
    v_cvt_pk_bf16_f32 v182, v124, v125
    v_cvt_pk_bf16_f32 v183, v126, v127
    v_rcp_f32 v192, v192
    v_rcp_f32 v193, v193
    v_mfma_f32_32x32x16_bf16 v[224:239], v[176:179], a[100:103], v[224:239]
    v_rcp_f32 v194, v194
    v_rcp_f32 v195, v195
    v_rcp_f32 v196, v196
    v_mfma_f32_32x32x16_bf16 v[208:223], v[180:183], a[104:107], v[208:223]
    v_rcp_f32 v197, v197
    v_rcp_f32 v198, v198
    v_rcp_f32 v199, v199
    v_mfma_f32_32x32x16_bf16 v[224:239], v[180:183], a[108:111], v[224:239]
    v_rcp_f32 v200, v200
    v_rcp_f32 v201, v201
    v_rcp_f32 v202, v202
    v_rcp_f32 v203, v203
    v_rcp_f32 v204, v204
    v_rcp_f32 v205, v205
    v_rcp_f32 v206, v206
    v_rcp_f32 v207, v207
    v_pk_mul_f32 v[128:129], v[128:129], v[192:193]
    v_pk_mul_f32 v[130:131], v[130:131], v[194:195]
    v_pk_mul_f32 v[132:133], v[132:133], v[196:197]
    v_pk_mul_f32 v[134:135], v[134:135], v[198:199]
    v_pk_mul_f32 v[136:137], v[136:137], v[200:201]
    v_pk_mul_f32 v[138:139], v[138:139], v[202:203]
    v_pk_mul_f32 v[140:141], v[140:141], v[204:205]
    v_pk_mul_f32 v[142:143], v[142:143], v[206:207]
    v_cvt_pk_bf16_f32 v192, v128, v129
    v_cvt_pk_bf16_f32 v193, v130, v131
    v_cvt_pk_bf16_f32 v194, v132, v133
    v_cvt_pk_bf16_f32 v195, v134, v135
    v_cvt_pk_bf16_f32 v196, v136, v137
    v_cvt_pk_bf16_f32 v197, v138, v139
    v_mfma_f32_32x32x16_bf16 v[208:223], v[192:195], a[112:115], v[208:223]
    v_cvt_pk_bf16_f32 v198, v140, v141
    v_cvt_pk_bf16_f32 v199, v142, v143
    v_lshrrev_b32 v15, 4, v13
    v_lshl_add_u32 v15, v15, 5, s25
    ds_read_b128 v[168:171], v15 offset:3200
    v_mfma_f32_32x32x16_bf16 v[208:223], v[196:199], a[120:123], v[208:223]
    ds_read_b32 v175, v15 offset:3228
    v_and_b32 v15, 15, v13
    v_lshrrev_b32 v240, 4, v11
    v_sub_u32 v240, s29, v240
    v_add_f32 v252, v252, v253
    v_mfma_f32_32x32x16_bf16 v[224:239], v[192:195], a[116:119], v[224:239]
    s_nop 2
    s_waitcnt lgkmcnt(0)
    v_lshl_add_u32 v168, v15, 3, v168
    v_lshl_add_u32 v169, v15, 3, v169
    v_mfma_f32_32x32x16_bf16 v[224:239], v[196:199], a[124:127], v[224:239]
    v_lshl_add_u32 v170, v15, 3, v170
    v_lshl_add_u32 v171, v15, 3, v171
    v_lshl_add_u32 v175, v15, 3, v175
    v_mov_b32 v20, 0
    v_mov_b32 v21, 1
    s_nop 3
    v_pk_add_f32 v[208:209], v[208:209], v[210:211]
    v_pk_add_f32 v[212:213], v[212:213], v[214:215]
    v_pk_add_f32 v[216:217], v[216:217], v[218:219]
    v_pk_add_f32 v[224:225], v[224:225], v[226:227]
    v_pk_add_f32 v[228:229], v[228:229], v[230:231]
    v_pk_add_f32 v[232:233], v[232:233], v[234:235]
    v_cmpx_lt_i32_e64 vcc, 24, v240
    v_pk_add_f32 v[220:221], v[220:221], v[222:223]
    v_pk_add_f32 v[236:237], v[236:237], v[238:239]
    s_mov_b64 exec, -1
    v_cvt_pk_bf16_f32 v176, v208, v224
    v_cvt_pk_bf16_f32 v177, v209, v225
    v_cvt_pk_bf16_f32 v180, v212, v228
    v_cvt_pk_bf16_f32 v181, v213, v229
    v_permlane16_swap_b32 v176, v177
    v_cvt_pk_bf16_f32 v184, v216, v232
    v_cvt_pk_bf16_f32 v185, v217, v233
    v_permlane16_swap_b32 v180, v181
    buffer_store_dwordx2 v[176:177], v168, s[8:11], 0 offen sc1
    v_cvt_pk_bf16_f32 v188, v220, v236
    v_cvt_pk_bf16_f32 v189, v221, v237
    v_permlane16_swap_b32 v184, v185
    buffer_store_dwordx2 v[180:181], v169, s[8:11], 0 offen sc1
    v_cvt_pk_bf16_f32 v190, v222, v238
    v_cvt_pk_bf16_f32 v191, v223, v239
    v_permlane16_swap_b32 v188, v189
    buffer_store_dwordx2 v[184:185], v170, s[8:11], 0 offen sc1
    v_maximum3_f32 v252, v252, |v208|, |v209|
    v_maximum3_f32 v252, v252, |v212|, |v213|
    v_permlane16_swap_b32 v190, v191
    buffer_store_dwordx2 v[188:189], v171, s[8:11], 0 offen sc1
    v_maximum3_f32 v252, v252, |v216|, |v217|
    v_maximum3_f32 v252, v252, |v220|, |v221|
    buffer_store_dwordx2 v[190:191], v175, s[8:11], 0 offen sc1
    v_maximum3_f32 v252, v252, |v222|, |v223|
    v_cmp_ngt_f32 vcc, 0x7e800000, v252
    s_or_b64 s[34:35], s[34:35], vcc
    s_mov_b64 exec, s[34:35]
    ds_write_b32 v20, v21 offset:1280
    s_mov_b64 exec, -1
    s_waitcnt lgkmcnt(0)
    s_barrier
    ds_read_b32 v21, v20 offset:1280
    s_waitcnt lgkmcnt(0)
    v_readfirstlane_b32 s27, v21
    s_cmp_lg_u32 s27, 0
    s_cbranch_scc1 K2_SLOW
K2_END:
    s_endpgm
K2_BUILD:
    s_sub_u32 s93, s2, 250
    s_lshl_b32 s93, s93, 2
    s_add_u32 s93, s93, s20
    s_mov_b32 s58, 33792
    s_mov_b32 s59, 0x00020000
    s_mov_b32 s62, 256
    s_mov_b32 s63, 0x00020000
    s_mov_b32 s66, 16384
    s_mov_b32 s67, 0x00020000
    s_mov_b32 s70, 128
    s_mov_b32 s71, 0x00020000
    v_and_b32 v96, 31, v13
    v_lshrrev_b32 v97, 5, v13
    v_lshlrev_b32 v98, 13, v97
    v_lshl_add_u32 v98, v96, 1, v98
    v_and_b32 v101, 15, v96
    v_lshrrev_b32 v100, 4, v96
    v_lshl_or_b32 v101, v101, 1, v100
    v_lshlrev_b32 v101, 2, v101
    v_lshl_add_u32 v99, v97, 9, v101
    v_lshlrev_b32 v100, 1, v96
    v_cmp_eq_u32 s[88:89], 1, v97
    s_and_b32 s95, s93, 3
    s_lshl_b32 s95, s95, 11
    s_bfe_u32 s99, s93, 0x20002
    s_lshl_b32 s99, s99, 6
    s_add_u32 s95, s95, s99
    s_lshr_b32 s99, s93, 4
    s_mul_i32 s90, s99, 19
    s_lshl_b32 s99, s99, 14
    s_add_u32 s95, s95, s99
    s_add_u32 s90, s90, s93
    s_lshl_b32 s90, s90, 10
    s_add_u32 s98, s93, 24
    s_and_b32 s96, s98, 3
    s_lshl_b32 s96, s96, 11
    s_bfe_u32 s99, s98, 0x20002
    s_lshl_b32 s99, s99, 6
    s_add_u32 s96, s96, s99
    s_lshr_b32 s99, s98, 4
    s_mul_i32 s91, s99, 19
    s_lshl_b32 s99, s99, 14
    s_add_u32 s96, s96, s99
    s_add_u32 s91, s91, s98
    s_lshl_b32 s91, s91, 10
    s_sub_u32 s99, s93, 8
    s_add_u32 s98, s99, 16
    s_lshl_b32 s98, s98, 10
    s_lshr_b32 s97, s99, 1
    s_lshl_b32 s97, s97, 11
    s_and_b32 s99, s99, 1
    s_lshl_b32 s99, s99, 1
    s_add_u32 s97, s97, s99
    s_cmp_ge_u32 s93, 8
    s_cselect_b32 s91, s98, s91
    s_cselect_b32 s96, s97, s96
    s_add_u32 s92, s93, 11
    s_lshl_b32 s92, s92, 10
    s_sub_u32 s97, s93, 21
    s_lshl_b32 s97, s97, 7
    s_add_u32 s97, s97, 32768
    s_waitcnt lgkmcnt(0)
    s_mov_b64 s[56:57], s[80:81]
    s_mov_b64 s[60:61], s[82:83]
    s_mov_b64 s[64:65], s[84:85]
    s_mov_b64 s[68:69], s[86:87]
    buffer_load_ushort v64, v98, s[56:59], s95 offen offset:0
    buffer_load_ushort v65, v98, s[56:59], s95 offen offset:256
    buffer_load_ushort v66, v98, s[56:59], s95 offen offset:512
    buffer_load_ushort v67, v98, s[56:59], s95 offen offset:768
    buffer_load_ushort v68, v98, s[56:59], s95 offen offset:1024
    buffer_load_ushort v69, v98, s[56:59], s95 offen offset:1280
    buffer_load_ushort v70, v98, s[56:59], s95 offen offset:1536
    buffer_load_ushort v71, v98, s[56:59], s95 offen offset:1792
    s_cmp_ge_u32 s93, 8
    s_cbranch_scc1 KB_W2
    buffer_load_ushort v72, v98, s[56:59], s96 offen offset:0
    buffer_load_ushort v73, v98, s[56:59], s96 offen offset:256
    buffer_load_ushort v74, v98, s[56:59], s96 offen offset:512
    buffer_load_ushort v75, v98, s[56:59], s96 offen offset:768
    buffer_load_ushort v76, v98, s[56:59], s96 offen offset:1024
    buffer_load_ushort v77, v98, s[56:59], s96 offen offset:1280
    buffer_load_ushort v78, v98, s[56:59], s96 offen offset:1536
    buffer_load_ushort v79, v98, s[56:59], s96 offen offset:1792
    s_mov_b32 s99, 0xbfb8aa3b
    s_branch KB_C
KB_W2:
    buffer_load_ushort v72, v99, s[64:67], s96 offen offset:0
    buffer_load_ushort v73, v99, s[64:67], s96 offen offset:128
    buffer_load_ushort v74, v99, s[64:67], s96 offen offset:256
    buffer_load_ushort v75, v99, s[64:67], s96 offen offset:384
    buffer_load_ushort v76, v99, s[64:67], s96 offen offset:1024
    buffer_load_ushort v77, v99, s[64:67], s96 offen offset:1152
    buffer_load_ushort v78, v99, s[64:67], s96 offen offset:1280
    buffer_load_ushort v79, v99, s[64:67], s96 offen offset:1408
    s_mov_b32 s99, 0xbf317218
    s_cmp_lt_u32 s93, 21
    s_cbranch_scc1 KB_C
    s_cmp_eq_u32 s93, 23
    s_cbranch_scc1 KB_B
    buffer_load_ushort v80, v100, s[56:59], s97 offen offset:0
    buffer_load_ushort v81, v100, s[56:59], s97 offen offset:256
    buffer_load_ushort v82, v100, s[56:59], s97 offen offset:512
    buffer_load_ushort v83, v100, s[56:59], s97 offen offset:768
    buffer_load_ushort v84, v100, s[56:59], s97 offen offset:64
    buffer_load_ushort v85, v100, s[56:59], s97 offen offset:320
    buffer_load_ushort v86, v100, s[56:59], s97 offen offset:576
    buffer_load_ushort v87, v100, s[56:59], s97 offen offset:832
    s_branch KB_C
KB_B:
    buffer_load_ushort v80, v100, s[60:63], 0 offen offset:0
    buffer_load_ushort v81, v100, s[60:63], 0 offen offset:64
    buffer_load_ushort v82, v100, s[60:63], 0 offen offset:128
    buffer_load_ushort v83, v100, s[60:63], 0 offen offset:192
    buffer_load_dword v102, v101, s[68:71], 0 offen
    v_mov_b32 v84, 0
    v_mov_b32 v85, 0
    v_mov_b32 v86, 0
    v_mov_b32 v87, 0
KB_C:
    s_mov_b32 s98, 0xbfb8aa3b
    s_and_b32 s21, s2, 7
    s_lshl_b32 s21, s21, 5
    s_lshr_b32 s3, s2, 3
    s_add_u32 s21, s21, s3
    v_lshlrev_b32 v19, 4, v16
    v_lshlrev_b32 v25, 4, v13
    v_and_b32 v36, 31, v13
    v_mul_u32_u24 v17, 516, v16
    v_add_u32 v17, 62080, v17
    v_lshlrev_b32 v18, 2, v16
    v_mov_b32 v20, 0
    v_mov_b32 v21, 0
    v_lshlrev_b32 v26, 3, v13
    ds_write_b32 v18, v17 offset:0
    ds_write_b64 v26, v[20:21] offset:1024
    ds_write_b32 v18, v20 offset:5120
    s_mov_b32 s18, 578560
    s_mov_b32 s19, 0x00020000
    s_mov_b32 s6, 6400000
    s_mov_b32 s7, 0x00020000
    s_mov_b32 s10, 6400000
    s_mov_b32 s11, 0x00020000
    s_mov_b32 s14, 9600000
    s_mov_b32 s15, 0x00020000
    s_mov_b32 s40, 53248
    s_add_u32 s16, s44, 9600000
    s_addc_u32 s17, s45, 0
    s_mov_b64 s[12:13], s[44:45]
    s_mov_b64 s[4:5], s[72:73]
    s_mov_b64 s[8:9], s[42:43]
    buffer_load_dwordx2 v[22:23], v20, s[16:19], s40 offen sc1
    s_waitcnt vmcnt(1)
    v_lshlrev_b32 v64, 16, v64
    v_mul_f32 v64, s98, v64
    v_lshlrev_b32 v65, 16, v65
    v_mul_f32 v65, s98, v65
    v_lshlrev_b32 v66, 16, v66
    v_mul_f32 v66, s98, v66
    v_lshlrev_b32 v67, 16, v67
    v_mul_f32 v67, s98, v67
    v_lshlrev_b32 v68, 16, v68
    v_mul_f32 v68, s98, v68
    v_lshlrev_b32 v69, 16, v69
    v_mul_f32 v69, s98, v69
    v_lshlrev_b32 v70, 16, v70
    v_mul_f32 v70, s98, v70
    v_lshlrev_b32 v71, 16, v71
    v_mul_f32 v71, s98, v71
    v_cvt_pk_bf16_f32 v108, v64, v65
    v_cvt_pk_bf16_f32 v109, v66, v67
    v_cvt_pk_bf16_f32 v110, v68, v69
    v_cvt_pk_bf16_f32 v111, v70, v71
    buffer_store_dwordx4 v[108:111], v25, s[16:19], s90 offen sc1
    v_lshlrev_b32 v72, 16, v72
    v_mul_f32 v72, s99, v72
    v_lshlrev_b32 v73, 16, v73
    v_mul_f32 v73, s99, v73
    v_lshlrev_b32 v74, 16, v74
    v_mul_f32 v74, s99, v74
    v_lshlrev_b32 v75, 16, v75
    v_mul_f32 v75, s99, v75
    v_lshlrev_b32 v76, 16, v76
    v_mul_f32 v76, s99, v76
    v_lshlrev_b32 v77, 16, v77
    v_mul_f32 v77, s99, v77
    v_lshlrev_b32 v78, 16, v78
    v_mul_f32 v78, s99, v78
    v_lshlrev_b32 v79, 16, v79
    v_mul_f32 v79, s99, v79
    v_cvt_pk_bf16_f32 v112, v72, v73
    v_cvt_pk_bf16_f32 v113, v74, v75
    v_cvt_pk_bf16_f32 v114, v76, v77
    v_cvt_pk_bf16_f32 v115, v78, v79
    buffer_store_dwordx4 v[112:115], v25, s[16:19], s91 offen sc1
    s_cmp_lt_u32 s93, 21
    s_cbranch_scc1 KB_E
    v_lshlrev_b32 v80, 16, v80
    v_mul_f32 v80, s98, v80
    v_lshlrev_b32 v81, 16, v81
    v_mul_f32 v81, s98, v81
    v_lshlrev_b32 v82, 16, v82
    v_mul_f32 v82, s98, v82
    v_lshlrev_b32 v83, 16, v83
    v_mul_f32 v83, s98, v83
    v_lshlrev_b32 v84, 16, v84
    v_mul_f32 v84, s98, v84
    v_lshlrev_b32 v85, 16, v85
    v_mul_f32 v85, s98, v85
    v_lshlrev_b32 v86, 16, v86
    v_mul_f32 v86, s98, v86
    v_lshlrev_b32 v87, 16, v87
    v_mul_f32 v87, s98, v87
    v_cvt_pk_bf16_f32 v88, v80, v81
    v_lshlrev_b32 v104, 16, v88
    v_and_b32 v105, 0xffff0000, v88
    v_sub_f32 v104, v80, v104
    v_sub_f32 v105, v81, v105
    v_cvt_pk_bf16_f32 v104, v104, v105
    v_cndmask_b32 v88, v88, v104, s[88:89]
    v_cvt_pk_bf16_f32 v89, v82, v83
    v_lshlrev_b32 v104, 16, v89
    v_and_b32 v105, 0xffff0000, v89
    v_sub_f32 v104, v82, v104
    v_sub_f32 v105, v83, v105
    v_cvt_pk_bf16_f32 v104, v104, v105
    v_cndmask_b32 v89, v89, v104, s[88:89]
    v_cvt_pk_bf16_f32 v90, v84, v85
    v_lshlrev_b32 v104, 16, v90
    v_and_b32 v105, 0xffff0000, v90
    v_sub_f32 v104, v84, v104
    v_sub_f32 v105, v85, v105
    v_cvt_pk_bf16_f32 v104, v104, v105
    v_cndmask_b32 v90, v90, v104, s[88:89]
    v_cvt_pk_bf16_f32 v91, v86, v87
    v_lshlrev_b32 v104, 16, v91
    v_and_b32 v105, 0xffff0000, v91
    v_sub_f32 v104, v86, v104
    v_sub_f32 v105, v87, v105
    v_cvt_pk_bf16_f32 v104, v104, v105
    v_cndmask_b32 v91, v91, v104, s[88:89]
    s_cmp_eq_u32 s93, 23
    s_cbranch_scc0 KB_S
    v_cndmask_b32 v90, v102, 0, s[88:89]
KB_S:
    buffer_store_dwordx4 v[88:91], v25, s[16:19], s92 offen sc1
KB_E:
    s_movk_i32 s22, 128
    s_mov_b64 s[34:35], 0
    s_mov_b32 s32, 0
    s_mov_b32 s41, 0xffff
    v_and_b32 v27, 15, v13
    v_not_b32 v28, v27
    v_mul_u32_u24 v27, 12, v27
    v_lshrrev_b32 v11, 5, v13
    v_lshlrev_b32 v11, 6, v11
    v_mov_b32 v33, 12
    v_lshrrev_b32 v34, 3, v13
    v_lshlrev_b32 v34, 4, v34
    v_xor_b32 v34, v34, v25
    v_mul_u32_u24 v31, 38400, v16
    v_bfe_u32 v29, v36, 2, 1
    v_and_b32 v30, 1, v36
    v_lshl_or_b32 v29, v29, 1, v30
    v_bfe_u32 v30, v36, 1, 1
    v_lshl_or_b32 v29, v29, 1, v30
    v_lshrrev_b32 v30, 3, v36
    v_lshl_or_b32 v29, v29, 2, v30
    v_lshlrev_b32 v29, 2, v29
    s_lshl_b32 s27, s21, 3
    s_add_u32 s27, s27, 54272
    v_lshlrev_b32 v24, 11, v16
    v_add_u32 v24, s27, v24
    v_min_u32 v35, 5, v13
    v_add_u32 v35, 250, v35
    v_lshlrev_b32 v35, 11, v35
    v_add_u32 v35, s27, v35
    s_lshl_b32 s3, s20, 3
    s_or_b32 s3, s3, 0x80000
    v_lshrrev_b32 v37, 2, v36
    v_and_b32 v38, 1, v36
    v_lshl_or_b32 v37, v37, 1, v38
    v_bfe_u32 v38, v36, 1, 1
    s_bfe_u32 s38, 0x4040400, s3
    s_bfe_u32 s46, 0x4020000, s3
    s_bfe_u32 s47, 0x84684c1e, s3
    s_sub_u32 s47, s47, s38
    v_cmp_gt_u32 vcc, s38, v36
    v_add_u32 v44, s47, v36
    v_add_u32 v39, s46, v37
    v_cndmask_b32 v44, v44, v39, vcc
    v_lshlrev_b32 v44, 3, v44
    v_cndmask_b32 v46, 0, 1, vcc
    v_and_b32 v47, v46, v38
    v_sub_u32 v45, v46, v47
    v_lshlrev_b32 v48, 30, v47
    v_mul_u32_u24 v47, 12, v47
    s_bfe_u32 s29, 0x18181c20, s3
    s_bfe_u32 s46, 0x6123ea0, s3
    s_bfe_u32 s47, 0xb0b8c000, s3
    s_sub_u32 s47, s47, s29
    v_cmp_gt_u32 vcc, s29, v36
    v_add_u32 v50, s47, v36
    v_add_u32 v39, s46, v37
    v_cndmask_b32 v50, v50, v39, vcc
    v_lshlrev_b32 v50, 3, v50
    v_cndmask_b32 v52, 0, 1, vcc
    v_and_b32 v53, v52, v38
    v_sub_u32 v51, v52, v53
    v_lshlrev_b32 v54, 30, v53
    v_mul_u32_u24 v53, 12, v53
    s_mul_i32 s33, s20, 6144
    s_mul_i32 s39, s21, 25088
    s_add_u32 s39, s39, s33
    s_mul_i32 s46, s20, 13312
    s_lshl_b32 s47, s2, 11
    s_add_u32 s47, s47, 54272
    s_waitcnt vmcnt(0) lgkmcnt(0)
    v_add_u32 v22, 1, v22
    v_and_b32 v23, 0xff000000, v23
    v_mov_b32 v40, v23
    v_mov_b32 v41, v22
    v_mov_b32 v42, v23
    v_mov_b32 v43, v22
    s_barrier
    s_cmp_ge_u32 s20, 2
    s_cselect_b64 exec, 0, -1
    buffer_store_dwordx4 v[40:43], v19, s[16:19], s47 offen sc1
    s_mov_b64 exec, -1
K2_WAITB:
    s_movk_i32 s84, 600
K2_WB1:
    buffer_load_dwordx2 v[56:57], v35, s[16:19], 0 offen sc1
    s_waitcnt vmcnt(0)
    v_xor_b32 v36, v56, v23
    v_xor_b32 v37, v57, v22
    v_lshrrev_b32 v36, 24, v36
    v_or_b32 v36, v36, v37
    v_cmp_ne_u32 vcc, 0, v36
    s_cbranch_vccz K2_WGO
    s_sub_u32 s84, s84, 1
    s_cbranch_scc0 K2_WB1
    s_mov_b32 s32, 2
    s_branch K2_WGO
K2_RARE1:
    buffer_load_dwordx3 v[176:178], v31, s[12:15], 0 offen offset:336 sc1
    buffer_load_dwordx3 v[180:182], v31, s[12:15], 0 offen offset:348 sc1
    buffer_load_dwordx3 v[184:186], v31, s[12:15], 0 offen offset:360 sc1
    buffer_load_dwordx3 v[188:190], v31, s[12:15], 0 offen offset:372 sc1
    buffer_load_dwordx3 v[192:194], v31, s[12:15], 0 offen offset:384 sc1
    buffer_load_dwordx3 v[196:198], v31, s[12:15], 0 offen offset:396 sc1
    buffer_load_dwordx3 v[200:202], v31, s[12:15], 0 offen offset:408 sc1
    buffer_load_dwordx3 v[204:206], v31, s[12:15], 0 offen offset:420 sc1
    buffer_load_dwordx3 v[208:210], v31, s[12:15], 0 offen offset:432 sc1
    buffer_load_dwordx3 v[212:214], v31, s[12:15], 0 offen offset:444 sc1
    buffer_load_dwordx3 v[216:218], v31, s[12:15], 0 offen offset:456 sc1
    buffer_load_dwordx3 v[220:222], v31, s[12:15], 0 offen offset:468 sc1
    v_cmp_lt_u32 vcc, 40, v32
    s_or_b64 s[34:35], s[34:35], vcc
    s_branch K2_P1
K2_RARE2:
    v_cmpx_lt_u32 vcc, 28, v32
    s_nop 0
    s_cbranch_execz K2_P3
    v_and_b32 v179, s41, v178
    ds_add_rtn_u32 v179, v179, v33
    s_waitcnt lgkmcnt(0)
    ds_write2_b32 v179, v176, v177 offset0:0 offset1:1
    ds_write_b32 v179, v178 offset:8
    v_cmpx_lt_u32 vcc, 29, v32
    s_nop 0
    s_cbranch_execz K2_P3
    v_and_b32 v183, s41, v182
    ds_add_rtn_u32 v183, v183, v33
    s_waitcnt lgkmcnt(0)
    ds_write2_b32 v183, v180, v181 offset0:0 offset1:1
    ds_write_b32 v183, v182 offset:8
    v_cmpx_lt_u32 vcc, 30, v32
    s_nop 0
    s_cbranch_execz K2_P3
    v_and_b32 v187, s41, v186
    ds_add_rtn_u32 v187, v187, v33
    s_waitcnt lgkmcnt(0)
    ds_write2_b32 v187, v184, v185 offset0:0 offset1:1
    ds_write_b32 v187, v186 offset:8
    v_cmpx_lt_u32 vcc, 31, v32
    s_nop 0
    s_cbranch_execz K2_P3
    v_and_b32 v191, s41, v190
    ds_add_rtn_u32 v191, v191, v33
    s_waitcnt lgkmcnt(0)
    ds_write2_b32 v191, v188, v189 offset0:0 offset1:1
    ds_write_b32 v191, v190 offset:8
    v_cmpx_lt_u32 vcc, 32, v32
    s_nop 0
    s_cbranch_execz K2_P3
    v_and_b32 v195, s41, v194
    ds_add_rtn_u32 v195, v195, v33
    s_waitcnt lgkmcnt(0)
    ds_write2_b32 v195, v192, v193 offset0:0 offset1:1
    ds_write_b32 v195, v194 offset:8
    v_cmpx_lt_u32 vcc, 33, v32
    s_nop 0
    s_cbranch_execz K2_P3
    v_and_b32 v199, s41, v198
    ds_add_rtn_u32 v199, v199, v33
    s_waitcnt lgkmcnt(0)
    ds_write2_b32 v199, v196, v197 offset0:0 offset1:1
    ds_write_b32 v199, v198 offset:8
    v_cmpx_lt_u32 vcc, 34, v32
    s_nop 0
    s_cbranch_execz K2_P3
    v_and_b32 v203, s41, v202
    ds_add_rtn_u32 v203, v203, v33
    s_waitcnt lgkmcnt(0)
    ds_write2_b32 v203, v200, v201 offset0:0 offset1:1
    ds_write_b32 v203, v202 offset:8
    v_cmpx_lt_u32 vcc, 35, v32
    s_nop 0
    s_cbranch_execz K2_P3
    v_and_b32 v207, s41, v206
    ds_add_rtn_u32 v207, v207, v33
    s_waitcnt lgkmcnt(0)
    ds_write2_b32 v207, v204, v205 offset0:0 offset1:1
    ds_write_b32 v207, v206 offset:8
    v_cmpx_lt_u32 vcc, 36, v32
    s_nop 0
    s_cbranch_execz K2_P3
    v_and_b32 v211, s41, v210
    ds_add_rtn_u32 v211, v211, v33
    s_waitcnt lgkmcnt(0)
    ds_write2_b32 v211, v208, v209 offset0:0 offset1:1
    ds_write_b32 v211, v210 offset:8
    v_cmpx_lt_u32 vcc, 37, v32
    s_nop 0
    s_cbranch_execz K2_P3
    v_and_b32 v215, s41, v214
    ds_add_rtn_u32 v215, v215, v33
    s_waitcnt lgkmcnt(0)
    ds_write2_b32 v215, v212, v213 offset0:0 offset1:1
    ds_write_b32 v215, v214 offset:8
    v_cmpx_lt_u32 vcc, 38, v32
    s_nop 0
    s_cbranch_execz K2_P3
    v_and_b32 v219, s41, v218
    ds_add_rtn_u32 v219, v219, v33
    s_waitcnt lgkmcnt(0)
    ds_write2_b32 v219, v216, v217 offset0:0 offset1:1
    ds_write_b32 v219, v218 offset:8
    v_cmpx_lt_u32 vcc, 39, v32
    s_nop 0
    s_cbranch_execz K2_P3
    v_and_b32 v223, s41, v222
    ds_add_rtn_u32 v223, v223, v33
    s_waitcnt lgkmcnt(0)
    ds_write2_b32 v223, v220, v221 offset0:0 offset1:1
    ds_write_b32 v223, v222 offset:8
    s_branch K2_P3
K2_TFIX:
    s_andn2_b64 exec, -1, s[30:31]
    v_mov_b32 v80, 0
    v_mov_b32 v144, 1.0
    v_mov_b32 v81, 0
    v_mov_b32 v145, 1.0
    v_mov_b32 v82, 0
    v_mov_b32 v146, 1.0
    v_mov_b32 v83, 0
    v_mov_b32 v147, 1.0
    v_mov_b32 v84, 0
    v_mov_b32 v148, 1.0
    v_mov_b32 v85, 0
    v_mov_b32 v149, 1.0
    v_mov_b32 v86, 0
    v_mov_b32 v150, 1.0
    v_mov_b32 v87, 0
    v_mov_b32 v151, 1.0
    v_mov_b32 v88, 0
    v_mov_b32 v152, 1.0
    v_mov_b32 v89, 0
    v_mov_b32 v153, 1.0
    v_mov_b32 v90, 0
    v_mov_b32 v154, 1.0
    v_mov_b32 v91, 0
    v_mov_b32 v155, 1.0
    v_mov_b32 v92, 0
    v_mov_b32 v156, 1.0
    v_mov_b32 v93, 0
    v_mov_b32 v157, 1.0
    v_mov_b32 v94, 0
    v_mov_b32 v158, 1.0
    v_mov_b32 v95, 0
    v_mov_b32 v159, 1.0
    v_mov_b32 v96, 0
    v_mov_b32 v160, 1.0
    v_mov_b32 v97, 0
    v_mov_b32 v161, 1.0
    v_mov_b32 v98, 0
    v_mov_b32 v162, 1.0
    v_mov_b32 v99, 0
    v_mov_b32 v163, 1.0
    v_mov_b32 v100, 0
    v_mov_b32 v164, 1.0
    v_mov_b32 v101, 0
    v_mov_b32 v165, 1.0
    v_mov_b32 v102, 0
    v_mov_b32 v166, 1.0
    v_mov_b32 v103, 0
    v_mov_b32 v167, 1.0
    v_mov_b32 v104, 0
    v_mov_b32 v168, 1.0
    v_mov_b32 v105, 0
    v_mov_b32 v169, 1.0
    v_mov_b32 v106, 0
    v_mov_b32 v170, 1.0
    v_mov_b32 v107, 0
    v_mov_b32 v171, 1.0
    v_mov_b32 v108, 0
    v_mov_b32 v172, 1.0
    v_mov_b32 v109, 0
    v_mov_b32 v173, 1.0
    v_mov_b32 v110, 0
    v_mov_b32 v174, 1.0
    v_mov_b32 v111, 0
    v_mov_b32 v175, 1.0
    v_mov_b32 v112, 0
    v_mov_b32 v176, 1.0
    v_mov_b32 v113, 0
    v_mov_b32 v177, 1.0
    v_mov_b32 v114, 0
    v_mov_b32 v178, 1.0
    v_mov_b32 v115, 0
    v_mov_b32 v179, 1.0
    v_mov_b32 v116, 0
    v_mov_b32 v180, 1.0
    v_mov_b32 v117, 0
    v_mov_b32 v181, 1.0
    v_mov_b32 v118, 0
    v_mov_b32 v182, 1.0
    v_mov_b32 v119, 0
    v_mov_b32 v183, 1.0
    v_mov_b32 v120, 0
    v_mov_b32 v184, 1.0
    v_mov_b32 v121, 0
    v_mov_b32 v185, 1.0
    v_mov_b32 v122, 0
    v_mov_b32 v186, 1.0
    v_mov_b32 v123, 0
    v_mov_b32 v187, 1.0
    v_mov_b32 v124, 0
    v_mov_b32 v188, 1.0
    v_mov_b32 v125, 0
    v_mov_b32 v189, 1.0
    v_mov_b32 v126, 0
    v_mov_b32 v190, 1.0
    v_mov_b32 v127, 0
    v_mov_b32 v191, 1.0
    v_mov_b32 v128, 0
    v_mov_b32 v192, 1.0
    v_mov_b32 v129, 0
    v_mov_b32 v193, 1.0
    v_mov_b32 v130, 0
    v_mov_b32 v194, 1.0
    v_mov_b32 v131, 0
    v_mov_b32 v195, 1.0
    v_mov_b32 v132, 0
    v_mov_b32 v196, 1.0
    v_mov_b32 v133, 0
    v_mov_b32 v197, 1.0
    v_mov_b32 v134, 0
    v_mov_b32 v198, 1.0
    v_mov_b32 v135, 0
    v_mov_b32 v199, 1.0
    v_mov_b32 v136, 0
    v_mov_b32 v200, 1.0
    v_mov_b32 v137, 0
    v_mov_b32 v201, 1.0
    v_mov_b32 v138, 0
    v_mov_b32 v202, 1.0
    v_mov_b32 v139, 0
    v_mov_b32 v203, 1.0
    v_mov_b32 v140, 0
    v_mov_b32 v204, 1.0
    v_mov_b32 v141, 0
    v_mov_b32 v205, 1.0
    v_mov_b32 v142, 0
    v_mov_b32 v206, 1.0
    v_mov_b32 v143, 0
    v_mov_b32 v207, 1.0
    s_mov_b64 exec, -1
    s_branch K2_TGO
K2_FFIX:
    s_andn2_b64 exec, -1, s[30:31]
    v_mov_b32 v80, 0
    v_mov_b32 v144, 1.0
    v_mov_b32 v81, 0
    v_mov_b32 v145, 1.0
    v_mov_b32 v82, 0
    v_mov_b32 v146, 1.0
    v_mov_b32 v83, 0
    v_mov_b32 v147, 1.0
    v_mov_b32 v84, 0
    v_mov_b32 v148, 1.0
    v_mov_b32 v85, 0
    v_mov_b32 v149, 1.0
    v_mov_b32 v86, 0
    v_mov_b32 v150, 1.0
    v_mov_b32 v87, 0
    v_mov_b32 v151, 1.0
    v_mov_b32 v88, 0
    v_mov_b32 v152, 1.0
    v_mov_b32 v89, 0
    v_mov_b32 v153, 1.0
    v_mov_b32 v90, 0
    v_mov_b32 v154, 1.0
    v_mov_b32 v91, 0
    v_mov_b32 v155, 1.0
    v_mov_b32 v92, 0
    v_mov_b32 v156, 1.0
    v_mov_b32 v93, 0
    v_mov_b32 v157, 1.0
    v_mov_b32 v94, 0
    v_mov_b32 v158, 1.0
    v_mov_b32 v95, 0
    v_mov_b32 v159, 1.0
    v_mov_b32 v96, 0
    v_mov_b32 v160, 1.0
    v_mov_b32 v97, 0
    v_mov_b32 v161, 1.0
    v_mov_b32 v98, 0
    v_mov_b32 v162, 1.0
    v_mov_b32 v99, 0
    v_mov_b32 v163, 1.0
    v_mov_b32 v100, 0
    v_mov_b32 v164, 1.0
    v_mov_b32 v101, 0
    v_mov_b32 v165, 1.0
    v_mov_b32 v102, 0
    v_mov_b32 v166, 1.0
    v_mov_b32 v103, 0
    v_mov_b32 v167, 1.0
    v_mov_b32 v104, 0
    v_mov_b32 v168, 1.0
    v_mov_b32 v105, 0
    v_mov_b32 v169, 1.0
    v_mov_b32 v106, 0
    v_mov_b32 v170, 1.0
    v_mov_b32 v107, 0
    v_mov_b32 v171, 1.0
    v_mov_b32 v108, 0
    v_mov_b32 v172, 1.0
    v_mov_b32 v109, 0
    v_mov_b32 v173, 1.0
    v_mov_b32 v110, 0
    v_mov_b32 v174, 1.0
    v_mov_b32 v111, 0
    v_mov_b32 v175, 1.0
    v_mov_b32 v112, 0
    v_mov_b32 v176, 1.0
    v_mov_b32 v113, 0
    v_mov_b32 v177, 1.0
    v_mov_b32 v114, 0
    v_mov_b32 v178, 1.0
    v_mov_b32 v115, 0
    v_mov_b32 v179, 1.0
    v_mov_b32 v116, 0
    v_mov_b32 v180, 1.0
    v_mov_b32 v117, 0
    v_mov_b32 v181, 1.0
    v_mov_b32 v118, 0
    v_mov_b32 v182, 1.0
    v_mov_b32 v119, 0
    v_mov_b32 v183, 1.0
    v_mov_b32 v120, 0
    v_mov_b32 v184, 1.0
    v_mov_b32 v121, 0
    v_mov_b32 v185, 1.0
    v_mov_b32 v122, 0
    v_mov_b32 v186, 1.0
    v_mov_b32 v123, 0
    v_mov_b32 v187, 1.0
    v_mov_b32 v124, 0
    v_mov_b32 v188, 1.0
    v_mov_b32 v125, 0
    v_mov_b32 v189, 1.0
    v_mov_b32 v126, 0
    v_mov_b32 v190, 1.0
    v_mov_b32 v127, 0
    v_mov_b32 v191, 1.0
    v_mov_b32 v128, 0
    v_mov_b32 v192, 1.0
    v_mov_b32 v129, 0
    v_mov_b32 v193, 1.0
    v_mov_b32 v130, 0
    v_mov_b32 v194, 1.0
    v_mov_b32 v131, 0
    v_mov_b32 v195, 1.0
    v_mov_b32 v132, 0
    v_mov_b32 v196, 1.0
    v_mov_b32 v133, 0
    v_mov_b32 v197, 1.0
    v_mov_b32 v134, 0
    v_mov_b32 v198, 1.0
    v_mov_b32 v135, 0
    v_mov_b32 v199, 1.0
    v_mov_b32 v136, 0
    v_mov_b32 v200, 1.0
    v_mov_b32 v137, 0
    v_mov_b32 v201, 1.0
    v_mov_b32 v138, 0
    v_mov_b32 v202, 1.0
    v_mov_b32 v139, 0
    v_mov_b32 v203, 1.0
    v_mov_b32 v140, 0
    v_mov_b32 v204, 1.0
    v_mov_b32 v141, 0
    v_mov_b32 v205, 1.0
    v_mov_b32 v142, 0
    v_mov_b32 v206, 1.0
    v_mov_b32 v143, 0
    v_mov_b32 v207, 1.0
    s_mov_b64 exec, -1
    s_branch K2_FGO
K2_SLOW:
    s_mov_b64 exec, -1
    s_mov_b32 s94, s27
    s_load_dwordx8 s[72:79], s[0:1], 32
    s_waitcnt vmcnt(0) lgkmcnt(0)
    s_mov_b32 s6, 6400000
    s_barrier
    s_lshl_b32 s27, s20, 6
    v_add_u32 v0, s27, v13
    v_lshlrev_b32 v23, 4, v13
    v_add_u32 v23, 29312, v23
    s_mov_b32 s93, s20
KS_BL:
    s_mov_b32 s58, 33792
    s_mov_b32 s59, 0x00020000
    s_mov_b32 s62, 256
    s_mov_b32 s63, 0x00020000
    s_mov_b32 s66, 16384
    s_mov_b32 s67, 0x00020000
    s_mov_b32 s70, 128
    s_mov_b32 s71, 0x00020000
    v_and_b32 v96, 31, v13
    v_lshrrev_b32 v97, 5, v13
    v_lshlrev_b32 v98, 13, v97
    v_lshl_add_u32 v98, v96, 1, v98
    v_and_b32 v101, 15, v96
    v_lshrrev_b32 v100, 4, v96
    v_lshl_or_b32 v101, v101, 1, v100
    v_lshlrev_b32 v101, 2, v101
    v_lshl_add_u32 v99, v97, 9, v101
    v_lshlrev_b32 v100, 1, v96
    v_cmp_eq_u32 s[88:89], 1, v97
    s_and_b32 s95, s93, 3
    s_lshl_b32 s95, s95, 11
    s_bfe_u32 s99, s93, 0x20002
    s_lshl_b32 s99, s99, 6
    s_add_u32 s95, s95, s99
    s_lshr_b32 s99, s93, 4
    s_mul_i32 s90, s99, 19
    s_lshl_b32 s99, s99, 14
    s_add_u32 s95, s95, s99
    s_add_u32 s90, s90, s93
    s_lshl_b32 s90, s90, 10
    s_add_u32 s98, s93, 24
    s_and_b32 s96, s98, 3
    s_lshl_b32 s96, s96, 11
    s_bfe_u32 s99, s98, 0x20002
    s_lshl_b32 s99, s99, 6
    s_add_u32 s96, s96, s99
    s_lshr_b32 s99, s98, 4
    s_mul_i32 s91, s99, 19
    s_lshl_b32 s99, s99, 14
    s_add_u32 s96, s96, s99
    s_add_u32 s91, s91, s98
    s_lshl_b32 s91, s91, 10
    s_sub_u32 s99, s93, 8
    s_add_u32 s98, s99, 16
    s_lshl_b32 s98, s98, 10
    s_lshr_b32 s97, s99, 1
    s_lshl_b32 s97, s97, 11
    s_and_b32 s99, s99, 1
    s_lshl_b32 s99, s99, 1
    s_add_u32 s97, s97, s99
    s_cmp_ge_u32 s93, 8
    s_cselect_b32 s91, s98, s91
    s_cselect_b32 s96, s97, s96
    s_add_u32 s92, s93, 11
    s_lshl_b32 s92, s92, 10
    s_sub_u32 s97, s93, 21
    s_lshl_b32 s97, s97, 7
    s_add_u32 s97, s97, 32768
    s_mov_b64 s[56:57], s[72:73]
    s_mov_b64 s[60:61], s[74:75]
    s_mov_b64 s[64:65], s[76:77]
    s_mov_b64 s[68:69], s[78:79]
    buffer_load_ushort v64, v98, s[56:59], s95 offen offset:0
    buffer_load_ushort v65, v98, s[56:59], s95 offen offset:256
    buffer_load_ushort v66, v98, s[56:59], s95 offen offset:512
    buffer_load_ushort v67, v98, s[56:59], s95 offen offset:768
    buffer_load_ushort v68, v98, s[56:59], s95 offen offset:1024
    buffer_load_ushort v69, v98, s[56:59], s95 offen offset:1280
    buffer_load_ushort v70, v98, s[56:59], s95 offen offset:1536
    buffer_load_ushort v71, v98, s[56:59], s95 offen offset:1792
    s_cmp_ge_u32 s93, 8
    s_cbranch_scc1 KSB_W2
    buffer_load_ushort v72, v98, s[56:59], s96 offen offset:0
    buffer_load_ushort v73, v98, s[56:59], s96 offen offset:256
    buffer_load_ushort v74, v98, s[56:59], s96 offen offset:512
    buffer_load_ushort v75, v98, s[56:59], s96 offen offset:768
    buffer_load_ushort v76, v98, s[56:59], s96 offen offset:1024
    buffer_load_ushort v77, v98, s[56:59], s96 offen offset:1280
    buffer_load_ushort v78, v98, s[56:59], s96 offen offset:1536
    buffer_load_ushort v79, v98, s[56:59], s96 offen offset:1792
    s_mov_b32 s99, 0xbfb8aa3b
    s_branch KSB_C
KSB_W2:
    buffer_load_ushort v72, v99, s[64:67], s96 offen offset:0
    buffer_load_ushort v73, v99, s[64:67], s96 offen offset:128
    buffer_load_ushort v74, v99, s[64:67], s96 offen offset:256
    buffer_load_ushort v75, v99, s[64:67], s96 offen offset:384
    buffer_load_ushort v76, v99, s[64:67], s96 offen offset:1024
    buffer_load_ushort v77, v99, s[64:67], s96 offen offset:1152
    buffer_load_ushort v78, v99, s[64:67], s96 offen offset:1280
    buffer_load_ushort v79, v99, s[64:67], s96 offen offset:1408
    s_mov_b32 s99, 0xbf317218
    s_cmp_lt_u32 s93, 21
    s_cbranch_scc1 KSB_C
    s_cmp_eq_u32 s93, 23
    s_cbranch_scc1 KSB_B
    buffer_load_ushort v80, v100, s[56:59], s97 offen offset:0
    buffer_load_ushort v81, v100, s[56:59], s97 offen offset:256
    buffer_load_ushort v82, v100, s[56:59], s97 offen offset:512
    buffer_load_ushort v83, v100, s[56:59], s97 offen offset:768
    buffer_load_ushort v84, v100, s[56:59], s97 offen offset:64
    buffer_load_ushort v85, v100, s[56:59], s97 offen offset:320
    buffer_load_ushort v86, v100, s[56:59], s97 offen offset:576
    buffer_load_ushort v87, v100, s[56:59], s97 offen offset:832
    s_branch KSB_C
KSB_B:
    buffer_load_ushort v80, v100, s[60:63], 0 offen offset:0
    buffer_load_ushort v81, v100, s[60:63], 0 offen offset:64
    buffer_load_ushort v82, v100, s[60:63], 0 offen offset:128
    buffer_load_ushort v83, v100, s[60:63], 0 offen offset:192
    buffer_load_dword v102, v101, s[68:71], 0 offen
    v_mov_b32 v84, 0
    v_mov_b32 v85, 0
    v_mov_b32 v86, 0
    v_mov_b32 v87, 0
KSB_C:
    s_mov_b32 s98, 0xbfb8aa3b
    s_waitcnt vmcnt(0)
    v_lshlrev_b32 v64, 16, v64
    v_mul_f32 v64, s98, v64
    v_lshlrev_b32 v65, 16, v65
    v_mul_f32 v65, s98, v65
    v_lshlrev_b32 v66, 16, v66
    v_mul_f32 v66, s98, v66
    v_lshlrev_b32 v67, 16, v67
    v_mul_f32 v67, s98, v67
    v_lshlrev_b32 v68, 16, v68
    v_mul_f32 v68, s98, v68
    v_lshlrev_b32 v69, 16, v69
    v_mul_f32 v69, s98, v69
    v_lshlrev_b32 v70, 16, v70
    v_mul_f32 v70, s98, v70
    v_lshlrev_b32 v71, 16, v71
    v_mul_f32 v71, s98, v71
    v_cvt_pk_bf16_f32 v108, v64, v65
    v_cvt_pk_bf16_f32 v109, v66, v67
    v_cvt_pk_bf16_f32 v110, v68, v69
    v_cvt_pk_bf16_f32 v111, v70, v71
    v_add_u32 v22, s90, v23
    ds_write_b128 v22, v[108:111]
    v_lshlrev_b32 v72, 16, v72
    v_mul_f32 v72, s99, v72
    v_lshlrev_b32 v73, 16, v73
    v_mul_f32 v73, s99, v73
    v_lshlrev_b32 v74, 16, v74
    v_mul_f32 v74, s99, v74
    v_lshlrev_b32 v75, 16, v75
    v_mul_f32 v75, s99, v75
    v_lshlrev_b32 v76, 16, v76
    v_mul_f32 v76, s99, v76
    v_lshlrev_b32 v77, 16, v77
    v_mul_f32 v77, s99, v77
    v_lshlrev_b32 v78, 16, v78
    v_mul_f32 v78, s99, v78
    v_lshlrev_b32 v79, 16, v79
    v_mul_f32 v79, s99, v79
    v_cvt_pk_bf16_f32 v112, v72, v73
    v_cvt_pk_bf16_f32 v113, v74, v75
    v_cvt_pk_bf16_f32 v114, v76, v77
    v_cvt_pk_bf16_f32 v115, v78, v79
    v_add_u32 v22, s91, v23
    ds_write_b128 v22, v[112:115]
    s_cmp_lt_u32 s93, 21
    s_cbranch_scc1 KSB_E
    v_lshlrev_b32 v80, 16, v80
    v_mul_f32 v80, s98, v80
    v_lshlrev_b32 v81, 16, v81
    v_mul_f32 v81, s98, v81
    v_lshlrev_b32 v82, 16, v82
    v_mul_f32 v82, s98, v82
    v_lshlrev_b32 v83, 16, v83
    v_mul_f32 v83, s98, v83
    v_lshlrev_b32 v84, 16, v84
    v_mul_f32 v84, s98, v84
    v_lshlrev_b32 v85, 16, v85
    v_mul_f32 v85, s98, v85
    v_lshlrev_b32 v86, 16, v86
    v_mul_f32 v86, s98, v86
    v_lshlrev_b32 v87, 16, v87
    v_mul_f32 v87, s98, v87
    v_cvt_pk_bf16_f32 v88, v80, v81
    v_lshlrev_b32 v104, 16, v88
    v_and_b32 v105, 0xffff0000, v88
    v_sub_f32 v104, v80, v104
    v_sub_f32 v105, v81, v105
    v_cvt_pk_bf16_f32 v104, v104, v105
    v_cndmask_b32 v88, v88, v104, s[88:89]
    v_cvt_pk_bf16_f32 v89, v82, v83
    v_lshlrev_b32 v104, 16, v89
    v_and_b32 v105, 0xffff0000, v89
    v_sub_f32 v104, v82, v104
    v_sub_f32 v105, v83, v105
    v_cvt_pk_bf16_f32 v104, v104, v105
    v_cndmask_b32 v89, v89, v104, s[88:89]
    v_cvt_pk_bf16_f32 v90, v84, v85
    v_lshlrev_b32 v104, 16, v90
    v_and_b32 v105, 0xffff0000, v90
    v_sub_f32 v104, v84, v104
    v_sub_f32 v105, v85, v105
    v_cvt_pk_bf16_f32 v104, v104, v105
    v_cndmask_b32 v90, v90, v104, s[88:89]
    v_cvt_pk_bf16_f32 v91, v86, v87
    v_lshlrev_b32 v104, 16, v91
    v_and_b32 v105, 0xffff0000, v91
    v_sub_f32 v104, v86, v104
    v_sub_f32 v105, v87, v105
    v_cvt_pk_bf16_f32 v104, v104, v105
    v_cndmask_b32 v91, v91, v104, s[88:89]
    s_cmp_eq_u32 s93, 23
    s_cbranch_scc0 KSB_S
    v_cndmask_b32 v90, v102, 0, s[88:89]
KSB_S:
    v_add_u32 v22, s92, v23
    ds_write_b128 v22, v[88:91]
KSB_E:
    s_add_u32 s93, s93, 4
    s_cmp_lt_u32 s93, 24
    s_cbranch_scc1 KS_BL
    s_waitcnt lgkmcnt(0)
    s_barrier
    ds_read_b128 a[0:3], v23 offset:0
    ds_read_b128 a[4:7], v23 offset:1024
    ds_read_b128 a[8:11], v23 offset:2048
    ds_read_b128 a[12:15], v23 offset:3072
    ds_read_b128 a[16:19], v23 offset:4096
    ds_read_b128 a[20:23], v23 offset:5120
    ds_read_b128 a[24:27], v23 offset:6144
    ds_read_b128 a[28:31], v23 offset:7168
    ds_read_b128 a[32:35], v23 offset:8192
    ds_read_b128 a[36:39], v23 offset:9216
    ds_read_b128 a[40:43], v23 offset:10240
    ds_read_b128 a[44:47], v23 offset:11264
    ds_read_b128 a[48:51], v23 offset:12288
    ds_read_b128 a[52:55], v23 offset:13312
    ds_read_b128 a[56:59], v23 offset:14336
    ds_read_b128 a[60:63], v23 offset:15360
    ds_read_b128 a[64:67], v23 offset:16384
    ds_read_b128 a[68:71], v23 offset:17408
    ds_read_b128 a[72:75], v23 offset:18432
    ds_read_b128 a[76:79], v23 offset:19456
    ds_read_b128 a[80:83], v23 offset:20480
    ds_read_b128 a[84:87], v23 offset:21504
    ds_read_b128 a[88:91], v23 offset:22528
    ds_read_b128 a[92:95], v23 offset:23552
    ds_read_b128 a[96:99], v23 offset:24576
    ds_read_b128 a[100:103], v23 offset:25600
    ds_read_b128 a[104:107], v23 offset:26624
    ds_read_b128 a[108:111], v23 offset:27648
    ds_read_b128 a[112:115], v23 offset:28672
    ds_read_b128 a[116:119], v23 offset:29696
    ds_read_b128 a[120:123], v23 offset:30720
    ds_read_b128 a[124:127], v23 offset:31744
    ds_read_b128 a[128:131], v23 offset:32768
    ds_read_b128 a[132:135], v23 offset:33792
    ds_read_b128 a[136:139], v23 offset:34816
    ds_read_b128 a[140:143], v23 offset:35840
    ds_read_b128 a[144:147], v23 offset:36864
    ds_read_b128 a[148:151], v23 offset:37888
    ds_read_b128 a[152:155], v23 offset:38912
    ds_read_b128 a[156:159], v23 offset:39936
    ds_read_b128 a[160:163], v23 offset:40960
    ds_read_b128 a[164:167], v23 offset:41984
    ds_read_b128 a[168:171], v23 offset:43008
    ds_read_b128 a[172:175], v23 offset:44032
    ds_read_b128 a[176:179], v23 offset:45056
    ds_read_b128 a[180:183], v23 offset:46080
    ds_read_b128 a[184:187], v23 offset:47104
    ds_read_b128 a[188:191], v23 offset:48128
    ds_read_b128 a[192:195], v23 offset:49152
    ds_read_b128 a[196:199], v23 offset:50176
    ds_read_b128 a[200:203], v23 offset:51200
    s_waitcnt lgkmcnt(0)
    s_barrier
KS_HAVE:
    s_load_dwordx8 s[72:79], s[0:1], 0
    v_lshlrev_b32 v20, 11, v0
    s_lshl_b32 s27, s21, 3
    s_add_u32 s27, s27, 54272
    buffer_load_dword v21, v20, s[16:19], s27 offen sc1
    v_mov_b32 v24, 0
    v_mov_b32 v25, 0
    v_mov_b32 v26, 0
    v_mov_b32 v27, 0
    v_lshlrev_b32 v22, 4, v0
    v_add_u32 v22, 62080, v22
    ds_write_b128 v22, v[24:27] offset:0
    ds_write_b128 v22, v[24:27] offset:4096
    ds_write_b128 v22, v[24:27] offset:8192
    ds_write_b128 v22, v[24:27] offset:12288
    ds_write_b128 v22, v[24:27] offset:16384
    ds_write_b128 v22, v[24:27] offset:20480
    ds_write_b128 v22, v[24:27] offset:24576
    ds_write_b128 v22, v[24:27] offset:28672
    ds_write_b128 v22, v[24:27] offset:32768
    ds_write_b128 v22, v[24:27] offset:36864
    ds_write_b128 v22, v[24:27] offset:40960
    ds_write_b128 v22, v[24:27] offset:45056
    ds_write_b128 v22, v[24:27] offset:49152
    v_mov_b32 v244, 0x3f80
    v_mov_b32 v245, 0
    v_mov_b32 v246, 1.0
    v_mov_b32 v247, 0
    v_mov_b32 v248, 0
    v_mov_b32 v249, 0x3f80
    v_mov_b32 v250, 0
    v_mov_b32 v251, 1.0
    v_mul_u32_u24 v1, 38400, v0
    v_and_b32 v6, 31, v13
    v_mul_u32_u24 v4, 12, v6
    v_lshlrev_b32 v6, 2, v6
    s_waitcnt vmcnt(0) lgkmcnt(0)
    v_and_b32 v22, 0xfff, v21
    v_bfe_u32 v2, v21, 12, 12
    v_mad_u32_u24 v1, v22, 12, v1
    v_mul_u32_u24 v2, 12, v2
    s_barrier
    s_mov_b32 s56, s78
    s_mov_b32 s57, s79
    s_mov_b32 s58, 3200000
    s_mov_b32 s59, 0x00020000
    s_mov_b32 s60, s76
    s_mov_b32 s61, s77
    s_mov_b32 s62, 3200000
    s_mov_b32 s63, 0x00020000
    s_mov_b32 s64, s74
    s_mov_b32 s65, s75
    s_mov_b32 s66, 6400000
    s_mov_b32 s67, 0x00020000
    s_mul_i32 s50, s21, 25088
    s_mul_i32 s51, s21, 196
    s_mov_b32 s46, 0
    s_lshl_b32 s95, s20, 7
    s_cmp_lt_u32 s94, 2
    s_cbranch_scc1 KS_SEG
KS_RAW:
    s_cmp_ge_u32 s95, 3200000
    s_cbranch_scc1 KS_DONE
    buffer_load_dword v20, v6, s[56:59], s95 offen
    s_mov_b32 s96, s95
    s_add_u32 s95, s95, 512
    s_waitcnt vmcnt(0)
    v_subrev_u32 v20, s51, v20
    v_cmp_gt_u32 vcc, 196, v20
    s_cbranch_vccz KS_RAW
    s_mov_b64 s[30:31], vcc
    s_lshl_b32 s97, s96, 1
    v_lshlrev_b32 v21, 1, v6
    buffer_load_dword v10, v6, s[60:63], s96 offen
    buffer_load_dwordx2 v[8:9], v21, s[64:67], s97 offen
    v_and_b32 v20, 0xff, v20
    v_lshlrev_b32 v20, 2, v20
    s_waitcnt vmcnt(0)
    v_lshl_or_b32 v10, v10, 16, v20
    s_branch KS_BODY
KS_SEG:
    s_nop 3
    v_readlane_b32 s47, v1, s46
    v_readlane_b32 s48, v2, s46
    s_mov_b32 s49, 0
KS_GRP:
    s_cmp_ge_u32 s49, s48
    s_cbranch_scc1 KS_NEXT
    v_add_u32 v20, s49, v4
    v_cmp_gt_u32 s[30:31], s48, v20
    v_add_u32 v20, s47, v20
    buffer_load_dwordx3 v[8:10], v20, s[12:15], 0 offen sc1
    s_waitcnt vmcnt(0)
KS_BODY:
    v_mad_u32_u16 v3, v10, s22, v11 op_sel:[1,0,0,0]
    buffer_load_dwordx4 a[204:207], v3, s[4:7], 0 offen offset:0
    buffer_load_dwordx4 a[208:211], v3, s[4:7], 0 offen offset:16
    buffer_load_dwordx4 a[212:215], v3, s[4:7], 0 offen offset:32
    buffer_load_dwordx4 a[216:219], v3, s[4:7], 0 offen offset:48
    v_and_b32 v20, 0xffff, v10
    v_lshl_add_u32 v3, v20, 5, v11
    v_add_u32 v3, s50, v3
    buffer_load_dwordx4 a[236:239], v3, s[4:7], 0 offen offset:0
    buffer_load_dwordx4 a[240:243], v3, s[4:7], 0 offen offset:16
    buffer_load_dwordx4 a[244:247], v3, s[4:7], 0 offen offset:32
    buffer_load_dwordx4 a[248:251], v3, s[4:7], 0 offen offset:48
    v_lshlrev_b32 v5, 6, v20
    v_add_u32 v5, v11, v5
    v_add_u32 v5, 62080, v5
    s_waitcnt vmcnt(0)
    v_mfma_f32_32x32x8_bf16 v[16:31], a[136:137], v[244:245], 0
    v_mfma_f32_32x32x16_bf16 v[16:31], a[140:143], a[236:239], v[16:31]
    v_mfma_f32_32x32x16_bf16 v[16:31], a[144:147], a[240:243], v[16:31]
    v_mfma_f32_32x32x16_bf16 v[16:31], a[148:151], a[244:247], v[16:31]
    v_mfma_f32_32x32x16_bf16 v[16:31], a[152:155], a[248:251], v[16:31]
    v_mfma_f32_32x32x8_bf16 v[16:31], a[128:129], v[8:9], v[16:31]
    v_mfma_f32_32x32x16_bf16 v[16:31], a[0:3], a[204:207], v[16:31]
    v_mfma_f32_32x32x16_bf16 v[16:31], a[4:7], a[208:211], v[16:31]
    v_mfma_f32_32x32x16_bf16 v[16:31], a[8:11], a[212:215], v[16:31]
    v_mfma_f32_32x32x16_bf16 v[16:31], a[12:15], a[216:219], v[16:31]
    v_mfma_f32_32x32x8_bf16 v[32:47], a[136:137], v[246:247], 0
    v_mfma_f32_32x32x16_bf16 v[32:47], a[156:159], a[236:239], v[32:47]
    v_mfma_f32_32x32x16_bf16 v[32:47], a[160:163], a[240:243], v[32:47]
    v_mfma_f32_32x32x16_bf16 v[32:47], a[164:167], a[244:247], v[32:47]
    v_mfma_f32_32x32x16_bf16 v[32:47], a[168:171], a[248:251], v[32:47]
    v_mfma_f32_32x32x8_bf16 v[32:47], a[130:131], v[8:9], v[32:47]
    v_mfma_f32_32x32x16_bf16 v[32:47], a[16:19], a[204:207], v[32:47]
    v_mfma_f32_32x32x16_bf16 v[32:47], a[20:23], a[208:211], v[32:47]
    v_mfma_f32_32x32x16_bf16 v[32:47], a[24:27], a[212:215], v[32:47]
    v_mfma_f32_32x32x16_bf16 v[32:47], a[28:31], a[216:219], v[32:47]
    v_mfma_f32_32x32x8_bf16 v[48:63], a[136:137], v[248:249], 0
    v_mfma_f32_32x32x16_bf16 v[48:63], a[172:175], a[236:239], v[48:63]
    v_mfma_f32_32x32x16_bf16 v[48:63], a[176:179], a[240:243], v[48:63]
    v_mfma_f32_32x32x16_bf16 v[48:63], a[180:183], a[244:247], v[48:63]
    v_mfma_f32_32x32x16_bf16 v[48:63], a[184:187], a[248:251], v[48:63]
    v_mfma_f32_32x32x8_bf16 v[48:63], a[132:133], v[8:9], v[48:63]
    v_mfma_f32_32x32x16_bf16 v[48:63], a[32:35], a[204:207], v[48:63]
    v_mfma_f32_32x32x16_bf16 v[48:63], a[36:39], a[208:211], v[48:63]
    v_mfma_f32_32x32x16_bf16 v[48:63], a[40:43], a[212:215], v[48:63]
    v_mfma_f32_32x32x16_bf16 v[48:63], a[44:47], a[216:219], v[48:63]
    v_mfma_f32_32x32x8_bf16 v[64:79], a[136:137], v[250:251], 0
    v_mfma_f32_32x32x16_bf16 v[64:79], a[188:191], a[236:239], v[64:79]
    v_mfma_f32_32x32x16_bf16 v[64:79], a[192:195], a[240:243], v[64:79]
    v_mfma_f32_32x32x16_bf16 v[64:79], a[196:199], a[244:247], v[64:79]
    v_mfma_f32_32x32x16_bf16 v[64:79], a[200:203], a[248:251], v[64:79]
    v_mfma_f32_32x32x8_bf16 v[64:79], a[134:135], v[8:9], v[64:79]
    v_mfma_f32_32x32x16_bf16 v[64:79], a[48:51], a[204:207], v[64:79]
    v_mfma_f32_32x32x16_bf16 v[64:79], a[52:55], a[208:211], v[64:79]
    v_mfma_f32_32x32x16_bf16 v[64:79], a[56:59], a[212:215], v[64:79]
    v_mfma_f32_32x32x16_bf16 v[64:79], a[60:63], a[216:219], v[64:79]
    v_mfma_f32_32x32x8_bf16 v[208:223], a[138:139], v[244:245], 0
    v_mfma_f32_32x32x8_bf16 v[224:239], a[138:139], v[246:247], 0
    s_nop 7
    s_nop 7
    v_exp_f32 v80, v16
    v_exp_f32 v81, v17
    v_exp_f32 v82, v18
    v_exp_f32 v83, v19
    v_exp_f32 v84, v20
    v_exp_f32 v85, v21
    v_exp_f32 v86, v22
    v_exp_f32 v87, v23
    v_exp_f32 v88, v24
    v_exp_f32 v89, v25
    v_exp_f32 v90, v26
    v_exp_f32 v91, v27
    v_exp_f32 v92, v28
    v_exp_f32 v93, v29
    v_exp_f32 v94, v30
    v_exp_f32 v95, v31
    v_exp_f32 v96, v32
    v_exp_f32 v97, v33
    v_exp_f32 v98, v34
    v_exp_f32 v99, v35
    v_exp_f32 v100, v36
    v_exp_f32 v101, v37
    v_exp_f32 v102, v38
    v_exp_f32 v103, v39
    v_exp_f32 v104, v40
    v_exp_f32 v105, v41
    v_exp_f32 v106, v42
    v_exp_f32 v107, v43
    v_exp_f32 v108, v44
    v_exp_f32 v109, v45
    v_exp_f32 v110, v46
    v_exp_f32 v111, v47
    v_exp_f32 v112, v48
    v_exp_f32 v113, v49
    v_exp_f32 v114, v50
    v_exp_f32 v115, v51
    v_exp_f32 v116, v52
    v_exp_f32 v117, v53
    v_exp_f32 v118, v54
    v_exp_f32 v119, v55
    v_exp_f32 v120, v56
    v_exp_f32 v121, v57
    v_exp_f32 v122, v58
    v_exp_f32 v123, v59
    v_exp_f32 v124, v60
    v_exp_f32 v125, v61
    v_exp_f32 v126, v62
    v_exp_f32 v127, v63
    v_exp_f32 v128, v64
    v_exp_f32 v129, v65
    v_exp_f32 v130, v66
    v_exp_f32 v131, v67
    v_exp_f32 v132, v68
    v_exp_f32 v133, v69
    v_exp_f32 v134, v70
    v_exp_f32 v135, v71
    v_exp_f32 v136, v72
    v_exp_f32 v137, v73
    v_exp_f32 v138, v74
    v_exp_f32 v139, v75
    v_exp_f32 v140, v76
    v_exp_f32 v141, v77
    v_exp_f32 v142, v78
    v_exp_f32 v143, v79
    v_add_f32 v80, 1.0, v80
    v_add_f32 v81, 1.0, v81
    v_add_f32 v82, 1.0, v82
    v_add_f32 v83, 1.0, v83
    v_add_f32 v84, 1.0, v84
    v_add_f32 v85, 1.0, v85
    v_add_f32 v86, 1.0, v86
    v_add_f32 v87, 1.0, v87
    v_add_f32 v88, 1.0, v88
    v_add_f32 v89, 1.0, v89
    v_add_f32 v90, 1.0, v90
    v_add_f32 v91, 1.0, v91
    v_add_f32 v92, 1.0, v92
    v_add_f32 v93, 1.0, v93
    v_add_f32 v94, 1.0, v94
    v_add_f32 v95, 1.0, v95
    v_add_f32 v96, 1.0, v96
    v_add_f32 v97, 1.0, v97
    v_add_f32 v98, 1.0, v98
    v_add_f32 v99, 1.0, v99
    v_add_f32 v100, 1.0, v100
    v_add_f32 v101, 1.0, v101
    v_add_f32 v102, 1.0, v102
    v_add_f32 v103, 1.0, v103
    v_add_f32 v104, 1.0, v104
    v_add_f32 v105, 1.0, v105
    v_add_f32 v106, 1.0, v106
    v_add_f32 v107, 1.0, v107
    v_add_f32 v108, 1.0, v108
    v_add_f32 v109, 1.0, v109
    v_add_f32 v110, 1.0, v110
    v_add_f32 v111, 1.0, v111
    v_add_f32 v112, 1.0, v112
    v_add_f32 v113, 1.0, v113
    v_add_f32 v114, 1.0, v114
    v_add_f32 v115, 1.0, v115
    v_add_f32 v116, 1.0, v116
    v_add_f32 v117, 1.0, v117
    v_add_f32 v118, 1.0, v118
    v_add_f32 v119, 1.0, v119
    v_add_f32 v120, 1.0, v120
    v_add_f32 v121, 1.0, v121
    v_add_f32 v122, 1.0, v122
    v_add_f32 v123, 1.0, v123
    v_add_f32 v124, 1.0, v124
    v_add_f32 v125, 1.0, v125
    v_add_f32 v126, 1.0, v126
    v_add_f32 v127, 1.0, v127
    v_add_f32 v128, 1.0, v128
    v_add_f32 v129, 1.0, v129
    v_add_f32 v130, 1.0, v130
    v_add_f32 v131, 1.0, v131
    v_add_f32 v132, 1.0, v132
    v_add_f32 v133, 1.0, v133
    v_add_f32 v134, 1.0, v134
    v_add_f32 v135, 1.0, v135
    v_add_f32 v136, 1.0, v136
    v_add_f32 v137, 1.0, v137
    v_add_f32 v138, 1.0, v138
    v_add_f32 v139, 1.0, v139
    v_add_f32 v140, 1.0, v140
    v_add_f32 v141, 1.0, v141
    v_add_f32 v142, 1.0, v142
    v_add_f32 v143, 1.0, v143
    v_rcp_f32 v80, v80
    v_rcp_f32 v81, v81
    v_rcp_f32 v82, v82
    v_rcp_f32 v83, v83
    v_rcp_f32 v84, v84
    v_rcp_f32 v85, v85
    v_rcp_f32 v86, v86
    v_rcp_f32 v87, v87
    v_rcp_f32 v88, v88
    v_rcp_f32 v89, v89
    v_rcp_f32 v90, v90
    v_rcp_f32 v91, v91
    v_rcp_f32 v92, v92
    v_rcp_f32 v93, v93
    v_rcp_f32 v94, v94
    v_rcp_f32 v95, v95
    v_rcp_f32 v96, v96
    v_rcp_f32 v97, v97
    v_rcp_f32 v98, v98
    v_rcp_f32 v99, v99
    v_rcp_f32 v100, v100
    v_rcp_f32 v101, v101
    v_rcp_f32 v102, v102
    v_rcp_f32 v103, v103
    v_rcp_f32 v104, v104
    v_rcp_f32 v105, v105
    v_rcp_f32 v106, v106
    v_rcp_f32 v107, v107
    v_rcp_f32 v108, v108
    v_rcp_f32 v109, v109
    v_rcp_f32 v110, v110
    v_rcp_f32 v111, v111
    v_rcp_f32 v112, v112
    v_rcp_f32 v113, v113
    v_rcp_f32 v114, v114
    v_rcp_f32 v115, v115
    v_rcp_f32 v116, v116
    v_rcp_f32 v117, v117
    v_rcp_f32 v118, v118
    v_rcp_f32 v119, v119
    v_rcp_f32 v120, v120
    v_rcp_f32 v121, v121
    v_rcp_f32 v122, v122
    v_rcp_f32 v123, v123
    v_rcp_f32 v124, v124
    v_rcp_f32 v125, v125
    v_rcp_f32 v126, v126
    v_rcp_f32 v127, v127
    v_rcp_f32 v128, v128
    v_rcp_f32 v129, v129
    v_rcp_f32 v130, v130
    v_rcp_f32 v131, v131
    v_rcp_f32 v132, v132
    v_rcp_f32 v133, v133
    v_rcp_f32 v134, v134
    v_rcp_f32 v135, v135
    v_rcp_f32 v136, v136
    v_rcp_f32 v137, v137
    v_rcp_f32 v138, v138
    v_rcp_f32 v139, v139
    v_rcp_f32 v140, v140
    v_rcp_f32 v141, v141
    v_rcp_f32 v142, v142
    v_rcp_f32 v143, v143
    v_mul_f32 v80, v80, v16
    v_mul_f32 v81, v81, v17
    v_mul_f32 v82, v82, v18
    v_mul_f32 v83, v83, v19
    v_mul_f32 v84, v84, v20
    v_mul_f32 v85, v85, v21
    v_mul_f32 v86, v86, v22
    v_mul_f32 v87, v87, v23
    v_mul_f32 v88, v88, v24
    v_mul_f32 v89, v89, v25
    v_mul_f32 v90, v90, v26
    v_mul_f32 v91, v91, v27
    v_mul_f32 v92, v92, v28
    v_mul_f32 v93, v93, v29
    v_mul_f32 v94, v94, v30
    v_mul_f32 v95, v95, v31
    v_mul_f32 v96, v96, v32
    v_mul_f32 v97, v97, v33
    v_mul_f32 v98, v98, v34
    v_mul_f32 v99, v99, v35
    v_mul_f32 v100, v100, v36
    v_mul_f32 v101, v101, v37
    v_mul_f32 v102, v102, v38
    v_mul_f32 v103, v103, v39
    v_mul_f32 v104, v104, v40
    v_mul_f32 v105, v105, v41
    v_mul_f32 v106, v106, v42
    v_mul_f32 v107, v107, v43
    v_mul_f32 v108, v108, v44
    v_mul_f32 v109, v109, v45
    v_mul_f32 v110, v110, v46
    v_mul_f32 v111, v111, v47
    v_mul_f32 v112, v112, v48
    v_mul_f32 v113, v113, v49
    v_mul_f32 v114, v114, v50
    v_mul_f32 v115, v115, v51
    v_mul_f32 v116, v116, v52
    v_mul_f32 v117, v117, v53
    v_mul_f32 v118, v118, v54
    v_mul_f32 v119, v119, v55
    v_mul_f32 v120, v120, v56
    v_mul_f32 v121, v121, v57
    v_mul_f32 v122, v122, v58
    v_mul_f32 v123, v123, v59
    v_mul_f32 v124, v124, v60
    v_mul_f32 v125, v125, v61
    v_mul_f32 v126, v126, v62
    v_mul_f32 v127, v127, v63
    v_mul_f32 v128, v128, v64
    v_mul_f32 v129, v129, v65
    v_mul_f32 v130, v130, v66
    v_mul_f32 v131, v131, v67
    v_mul_f32 v132, v132, v68
    v_mul_f32 v133, v133, v69
    v_mul_f32 v134, v134, v70
    v_mul_f32 v135, v135, v71
    v_mul_f32 v136, v136, v72
    v_mul_f32 v137, v137, v73
    v_mul_f32 v138, v138, v74
    v_mul_f32 v139, v139, v75
    v_mul_f32 v140, v140, v76
    v_mul_f32 v141, v141, v77
    v_mul_f32 v142, v142, v78
    v_mul_f32 v143, v143, v79
    v_cvt_pk_bf16_f32 v144, v80, v81
    v_cvt_pk_bf16_f32 v145, v82, v83
    v_cvt_pk_bf16_f32 v146, v84, v85
    v_cvt_pk_bf16_f32 v147, v86, v87
    v_cvt_pk_bf16_f32 v148, v88, v89
    v_cvt_pk_bf16_f32 v149, v90, v91
    v_cvt_pk_bf16_f32 v150, v92, v93
    v_cvt_pk_bf16_f32 v151, v94, v95
    v_cvt_pk_bf16_f32 v152, v96, v97
    v_cvt_pk_bf16_f32 v153, v98, v99
    v_cvt_pk_bf16_f32 v154, v100, v101
    v_cvt_pk_bf16_f32 v155, v102, v103
    v_cvt_pk_bf16_f32 v156, v104, v105
    v_cvt_pk_bf16_f32 v157, v106, v107
    v_cvt_pk_bf16_f32 v158, v108, v109
    v_cvt_pk_bf16_f32 v159, v110, v111
    v_cvt_pk_bf16_f32 v160, v112, v113
    v_cvt_pk_bf16_f32 v161, v114, v115
    v_cvt_pk_bf16_f32 v162, v116, v117
    v_cvt_pk_bf16_f32 v163, v118, v119
    v_cvt_pk_bf16_f32 v164, v120, v121
    v_cvt_pk_bf16_f32 v165, v122, v123
    v_cvt_pk_bf16_f32 v166, v124, v125
    v_cvt_pk_bf16_f32 v167, v126, v127
    v_cvt_pk_bf16_f32 v168, v128, v129
    v_cvt_pk_bf16_f32 v169, v130, v131
    v_cvt_pk_bf16_f32 v170, v132, v133
    v_cvt_pk_bf16_f32 v171, v134, v135
    v_cvt_pk_bf16_f32 v172, v136, v137
    v_cvt_pk_bf16_f32 v173, v138, v139
    v_cvt_pk_bf16_f32 v174, v140, v141
    v_cvt_pk_bf16_f32 v175, v142, v143
    s_nop 1
    v_mfma_f32_32x32x16_bf16 v[208:223], a[64:67], v[144:147], v[208:223]
    v_mfma_f32_32x32x16_bf16 v[224:239], a[68:71], v[144:147], v[224:239]
    v_mfma_f32_32x32x16_bf16 v[208:223], a[72:75], v[148:151], v[208:223]
    v_mfma_f32_32x32x16_bf16 v[224:239], a[76:79], v[148:151], v[224:239]
    v_mfma_f32_32x32x16_bf16 v[208:223], a[80:83], v[152:155], v[208:223]
    v_mfma_f32_32x32x16_bf16 v[224:239], a[84:87], v[152:155], v[224:239]
    v_mfma_f32_32x32x16_bf16 v[208:223], a[88:91], v[156:159], v[208:223]
    v_mfma_f32_32x32x16_bf16 v[224:239], a[92:95], v[156:159], v[224:239]
    v_mfma_f32_32x32x16_bf16 v[208:223], a[96:99], v[160:163], v[208:223]
    v_mfma_f32_32x32x16_bf16 v[224:239], a[100:103], v[160:163], v[224:239]
    v_mfma_f32_32x32x16_bf16 v[208:223], a[104:107], v[164:167], v[208:223]
    v_mfma_f32_32x32x16_bf16 v[224:239], a[108:111], v[164:167], v[224:239]
    v_mfma_f32_32x32x16_bf16 v[208:223], a[112:115], v[168:171], v[208:223]
    v_mfma_f32_32x32x16_bf16 v[224:239], a[116:119], v[168:171], v[224:239]
    v_mfma_f32_32x32x16_bf16 v[208:223], a[120:123], v[172:175], v[208:223]
    v_mfma_f32_32x32x16_bf16 v[224:239], a[124:127], v[172:175], v[224:239]
    s_nop 7
    s_nop 7
    s_mov_b64 exec, s[30:31]
    ds_add_f32 v5, v208 offset:0
    ds_add_f32 v5, v209 offset:16
    ds_add_f32 v5, v210 offset:32
    ds_add_f32 v5, v211 offset:48
    ds_add_f32 v5, v212 offset:128
    ds_add_f32 v5, v213 offset:144
    ds_add_f32 v5, v214 offset:160
    ds_add_f32 v5, v215 offset:176
    ds_add_f32 v5, v216 offset:8
    ds_add_f32 v5, v217 offset:24
    ds_add_f32 v5, v218 offset:40
    ds_add_f32 v5, v219 offset:56
    ds_add_f32 v5, v220 offset:136
    ds_add_f32 v5, v221 offset:152
    ds_add_f32 v5, v222 offset:168
    ds_add_f32 v5, v223 offset:184
    ds_add_f32 v5, v224 offset:4
    ds_add_f32 v5, v225 offset:20
    ds_add_f32 v5, v226 offset:36
    ds_add_f32 v5, v227 offset:52
    ds_add_f32 v5, v228 offset:132
    ds_add_f32 v5, v229 offset:148
    ds_add_f32 v5, v230 offset:164
    ds_add_f32 v5, v231 offset:180
    ds_add_f32 v5, v232 offset:12
    ds_add_f32 v5, v233 offset:28
    ds_add_f32 v5, v234 offset:44
    ds_add_f32 v5, v235 offset:60
    ds_add_f32 v5, v236 offset:140
    ds_add_f32 v5, v237 offset:156
    ds_add_f32 v5, v238 offset:172
    ds_add_f32 v5, v239 offset:188
    s_mov_b64 exec, -1
    s_waitcnt lgkmcnt(0)
    s_cmp_ge_u32 s94, 2
    s_cbranch_scc1 KS_RAW
    s_add_u32 s49, s49, 384
    s_branch KS_GRP
KS_NEXT:
    s_add_u32 s46, s46, 1
    s_cmp_lt_u32 s46, 64
    s_cbranch_scc1 KS_SEG
KS_DONE:
    s_waitcnt lgkmcnt(0)
    s_barrier
    v_lshlrev_b32 v20, 5, v0
    v_add_u32 v20, 62080, v20
    v_lshlrev_b32 v21, 4, v0
    v_add_u32 v21, s50, v21
    ds_read_b128 v[24:27], v20 offset:0
    ds_read_b128 v[28:31], v20 offset:16
    s_waitcnt lgkmcnt(0)
    v_cvt_pk_bf16_f32 v32, v24, v25
    v_cvt_pk_bf16_f32 v33, v26, v27
    v_cvt_pk_bf16_f32 v34, v28, v29
    v_cvt_pk_bf16_f32 v35, v30, v31
    buffer_store_dwordx4 v[32:35], v21, s[8:11], 0 offen
    s_nop 1
    v_add_u32 v21, 4096, v21
    ds_read_b128 v[24:27], v20 offset:8192
    ds_read_b128 v[28:31], v20 offset:8208
    s_waitcnt lgkmcnt(0)
    v_cvt_pk_bf16_f32 v32, v24, v25
    v_cvt_pk_bf16_f32 v33, v26, v27
    v_cvt_pk_bf16_f32 v34, v28, v29
    v_cvt_pk_bf16_f32 v35, v30, v31
    buffer_store_dwordx4 v[32:35], v21, s[8:11], 0 offen
    s_nop 1
    v_add_u32 v21, 4096, v21
    ds_read_b128 v[24:27], v20 offset:16384
    ds_read_b128 v[28:31], v20 offset:16400
    s_waitcnt lgkmcnt(0)
    v_cvt_pk_bf16_f32 v32, v24, v25
    v_cvt_pk_bf16_f32 v33, v26, v27
    v_cvt_pk_bf16_f32 v34, v28, v29
    v_cvt_pk_bf16_f32 v35, v30, v31
    buffer_store_dwordx4 v[32:35], v21, s[8:11], 0 offen
    s_nop 1
    v_add_u32 v21, 4096, v21
    ds_read_b128 v[24:27], v20 offset:24576
    ds_read_b128 v[28:31], v20 offset:24592
    s_waitcnt lgkmcnt(0)
    v_cvt_pk_bf16_f32 v32, v24, v25
    v_cvt_pk_bf16_f32 v33, v26, v27
    v_cvt_pk_bf16_f32 v34, v28, v29
    v_cvt_pk_bf16_f32 v35, v30, v31
    buffer_store_dwordx4 v[32:35], v21, s[8:11], 0 offen
    s_nop 1
    v_add_u32 v21, 4096, v21
    ds_read_b128 v[24:27], v20 offset:32768
    ds_read_b128 v[28:31], v20 offset:32784
    s_waitcnt lgkmcnt(0)
    v_cvt_pk_bf16_f32 v32, v24, v25
    v_cvt_pk_bf16_f32 v33, v26, v27
    v_cvt_pk_bf16_f32 v34, v28, v29
    v_cvt_pk_bf16_f32 v35, v30, v31
    buffer_store_dwordx4 v[32:35], v21, s[8:11], 0 offen
    s_nop 1
    v_add_u32 v21, 4096, v21
    ds_read_b128 v[24:27], v20 offset:40960
    ds_read_b128 v[28:31], v20 offset:40976
    s_waitcnt lgkmcnt(0)
    v_cvt_pk_bf16_f32 v32, v24, v25
    v_cvt_pk_bf16_f32 v33, v26, v27
    v_cvt_pk_bf16_f32 v34, v28, v29
    v_cvt_pk_bf16_f32 v35, v30, v31
    buffer_store_dwordx4 v[32:35], v21, s[8:11], 0 offen
    s_nop 1
    v_add_u32 v21, 4096, v21
    v_cmp_gt_u32 vcc, 32, v0
    s_and_saveexec_b64 s[46:47], vcc
    s_cbranch_execz KS_END
    ds_read_b128 v[24:27], v20 offset:49152
    ds_read_b128 v[28:31], v20 offset:49168
    s_waitcnt lgkmcnt(0)
    v_cvt_pk_bf16_f32 v32, v24, v25
    v_cvt_pk_bf16_f32 v33, v26, v27
    v_cvt_pk_bf16_f32 v34, v28, v29
    v_cvt_pk_bf16_f32 v35, v30, v31
    buffer_store_dwordx4 v[32:35], v21, s[8:11], 0 offen
    s_nop 1
    v_add_u32 v21, 4096, v21
KS_END:
    s_endpgm
.section .rodata,"a"
.p2align 6
.amdhsa_kernel standalone__edge_featured_mpnn_mpnn__graph_kernel
  .amdhsa_next_free_vgpr 512
  .amdhsa_next_free_sgpr 102
  .amdhsa_accum_offset 256
  .amdhsa_group_segment_fixed_size 0
  .amdhsa_kernarg_size 88
  .amdhsa_user_sgpr_count 2
  .amdhsa_user_sgpr_kernarg_segment_ptr 1
  .amdhsa_system_sgpr_workgroup_id_x 1
  .amdhsa_float_denorm_mode_32 3
.end_amdhsa_kernel
```
